```python
import torch

def _softmax(x, axis=-1):
    return torch.softmax(x, dim=axis)
def _gelu(x):
    return torch.nn.functional.gelu(x, approximate="tanh")
def _silu(x):
    return torch.nn.functional.silu(x)
def _sigmoid(x):
    return torch.sigmoid(x)
def _layernorm(x, axis=-1, eps=1e-5):
    m = x.mean(dim=axis, keepdim=True)
    v = x.var(dim=axis, keepdim=True, unbiased=False)
    return (x - m) / torch.sqrt(v + eps)
def _scatter_add(tgt, idx, src, axis=0):
    return tgt.clone().index_add_(axis, idx, src)
def _segment_sum(src, seg, n):
    out = torch.zeros((n,) + src.shape[1:], dtype=src.dtype)
    return out.index_add_(0, seg, src)
def _pad(x, pw):
    flat = tuple(v for pair in reversed(pw) for v in pair)
    return torch.nn.functional.pad(x, flat)

kernel_name = 'gated_mix__grouped_kv_mqa__linear_kernel_hedgehog__prompt'

def setup_inputs():

    _w = (lambda a: (lambda t: t.to(torch.bfloat16) if t.is_floating_point() else t)(torch.as_tensor(a)))
    def _A_setup():
        B, S, D, H = 1, 2048, 512, 32
        Dh = D // H
        return {
            "x": _w((lambda *s: torch.randn(*s, dtype=torch.bfloat16) * 0.05)(B, S, D)),
            "wq": _w((lambda *s: torch.randn(*s, dtype=torch.bfloat16) * 1.6)(D, H * Dh)),
            "wk": _w((lambda *s: torch.randn(*s, dtype=torch.bfloat16) * 1.6)(D, Dh)),
            "wv": _w((lambda *s: torch.randn(*s, dtype=torch.bfloat16) * 0.05)(D, Dh)),
            "wo": _w((lambda *s: torch.randn(*s, dtype=torch.bfloat16) * 0.05)(H * Dh, D)),
        }
    _A_in = _A_setup()

    def _B_setup():
        B, S, D, H = 1, 2048, 512, 32
        Dh = D // H
        return {
            "x": _w((lambda *s: torch.randn(*s, dtype=torch.bfloat16) * 0.05)(B, S, D)),
            "wqkv": _w((lambda *s: torch.randn(*s, dtype=torch.bfloat16) * 1.6)(D, 3 * D)),
            "w_phi": _w((lambda *s: torch.randn(*s, dtype=torch.bfloat16) * 1.6)(H, Dh, Dh) * (Dh ** -0.5)),
            "wo": _w((lambda *s: torch.randn(*s, dtype=torch.bfloat16) * 0.05)(D, D)),
        }
    _B_in = _B_setup()

    return {
        "A_x": _A_in["x"],
        "A_wq": _A_in["wq"],
        "A_wk": _A_in["wk"],
        "A_wv": _A_in["wv"],
        "A_wo": _A_in["wo"],
        "B_x": _B_in["x"],
        "B_wqkv": _B_in["wqkv"],
        "B_w_phi": _B_in["w_phi"],
        "B_wo": _B_in["wo"],
        "gate_w": _w((lambda *s: torch.randn(*s, dtype=torch.bfloat16) * 0.05)(512) * 16.0),
    }

def reference(A_x, A_wq, A_wk, A_wv, A_wo, B_x, B_wqkv, B_w_phi, B_wo, gate_w):
    def _A_ref(x, wq, wk, wv, wo):
        B, S, D = x.shape
        H = 32
        Dh = D // H
        q = (lambda x, *d: x.permute(*d))((x @ wq).reshape(B, S, H, Dh), 0, 2, 1, 3)
        k = x @ wk
        v = x @ wv
        scores = torch.einsum("bhqd,bkd->bhqk", q, k) * (Dh ** -0.5)
        p = _softmax(scores, axis=-1)
        o = torch.einsum("bhqk,bkd->bhqd", p, v)
        return (lambda x, *d: x.permute(*d))(o, 0, 2, 1, 3).reshape(B, S, H * Dh) @ wo

    def _B_ref(x, wqkv, w_phi, wo):
        B, S, D = x.shape
        H = 32; Dh = D // H
        qkv = (lambda x, *d: x.permute(*d))((x @ wqkv).reshape(B, S, 3, H, Dh), 2, 0, 3, 1, 4)
        q, k, v = qkv[0], qkv[1], qkv[2]
        pq = torch.einsum("bhsd,hdf->bhsf", q, w_phi)
        pk = torch.einsum("bhsd,hdf->bhsf", k, w_phi)
        phi_q = torch.concatenate([_softmax(pq, axis=-1), _softmax(-pq, axis=-1)], axis=-1)
        phi_k = torch.concatenate([_softmax(pk, axis=-1), _softmax(-pk, axis=-1)], axis=-1)
        kv = torch.einsum("bhsf,bhsd->bhfd", phi_k, v)
        z  = torch.einsum("bhsf->bhf", phi_k)
        num = torch.einsum("bhqf,bhfd->bhqd", phi_q, kv)
        den = torch.einsum("bhqf,bhf->bhq", phi_q, z)[..., None] + 1e-6
        o = num / den
        return (lambda x, *d: x.permute(*d))(o, 0, 2, 1, 3).reshape(B, S, D) @ wo

    x = A_x
    g = _sigmoid((x * gate_w).sum(-1, keepdims=True))
    a = _A_ref(x, A_wq, A_wk, A_wv, A_wo)
    b = _B_ref(x, B_wqkv, B_w_phi, B_wo)
    return g * a + (1 - g) * b
```

```asm
; @launch grid=(256,1,1) block=(512,1,1) lds=163840
.amdgcn_target "amdgcn-amd-amdhsa--gfx950"
.text
.globl gated_mix__grouped_kv_mqa__linear_kernel_hedgehog__prompt_kernel
.p2align 12
.p2align 8
.type gated_mix__grouped_kv_mqa__linear_kernel_hedgehog__prompt_kernel,@function
gated_mix__grouped_kv_mqa__linear_kernel_hedgehog__prompt_kernel:
    s_load_dwordx2 s[8:9], s[0:1], 0
    s_load_dwordx4 s[4:7], s[0:1], 16
    s_load_dwordx2 s[32:33], s[0:1], 56
    s_load_dwordx2 s[28:29], s[0:1], 72
    s_load_dwordx2 s[24:25], s[0:1], 96
    s_getpc_b64 s[90:91]
L_pc:
    s_lshl_b32 s3, s2, 7
    s_and_b32 s3, s3, 0x7c00
    v_and_b32 v1, 0x1c0, v0
    v_lshl_add_u32 v1, v1, 1, s3
    v_and_b32 v2, 1, v0
    v_lshl_add_u32 v1, v2, 15, v1
    v_min_u32 v124, CODE_BYTES, v1
    v_mov_b32 v125, 0
    v_lshl_add_u64 v[124:125], v[124:125], 0, s[90:91]
    global_load_dword v127, v[124:125], off
    s_cmp_ge_u32 s2, 0x100
    s_cbranch_scc1 L_exit
    v_lshrrev_b32 v1, 6, v0
    s_and_b32 s69, s2, 7
    s_bfe_u32 s54, s2, 0x30003
    v_readfirstlane_b32 s52, v1
    v_lshrrev_b32 v6, 3, v0
    s_lshr_b32 s70, s2, 6
    v_and_b32 v2, 7, v0
    s_lshl2_add_u32 s53, s69, s70
    v_bfe_u32 v3, v0, 4, 3
    s_lshl1_add_u32 s55, s70, s54
    v_xor_b32 v3, v3, v2
    s_add_u32 s55, s55, s69
    v_lshlrev_b32 v4, 10, v6
    s_and_b32 s55, s55, 7
    v_lshl_add_u32 v3, v3, 4, v4
    s_lshl_b32 s59, s52, 10
    s_lshl_b32 s76, s53, 16
    s_mov_b32 s10, 0x200000
    s_mov_b32 s11, 0x20000
    s_lshl_b32 s69, s55, 7
    s_add_u32 m0, s59, 32768
    s_add_u32 s69, s69, s76
    s_waitcnt lgkmcnt(0)
    buffer_load_dwordx4 v3, s[8:11], s69 offen lds
    s_load_dwordx2 s[16:17], s[0:1], 8
    s_mov_b32 s74, 839912457
    s_mov_b32 s75, 305136654
    v_and_b32 v7, 63, v0
    s_lshr_b32 s70, s2, 2
    s_and_b32 s70, s70, 62
    v_lshlrev_b32 v1, 4, v7
    s_lshr_b64 s[74:75], s[74:75], s70
    s_and_b32 s56, s74, 3
    s_add_u32 s73, s54, 4
    s_and_b32 s73, s73, 7
    s_mov_b32 s22, 0x4000
    s_mov_b32 s23, 0x20000
    s_mov_b32 s30, 0x400
    s_mov_b32 s31, 0x20000
    s_mov_b32 s34, 0x4000
    s_mov_b32 s35, 0x20000
    s_and_b32 s69, s52, 6
    s_cmp_eq_u32 s69, 2
    s_cbranch_scc0 L_nophi
    s_lshl_b32 s69, s73, 11
    s_add_u32 m0, s59, 24896
    s_add_u32 s69, s69, s59
    s_sub_u32 s69, s69, 2048
    buffer_load_dwordx4 v1, s[32:35], s69 offen lds
L_nophi:
    s_sub_u32 s72, s56, 1
    s_cmp_lt_u32 s72, 2
    s_cselect_b32 s69, s72, s52
    s_cmp_eq_u32 s69, 1
    s_cselect_b64 s[20:21], s[6:7], s[4:5]
    s_cmp_lt_u32 s72, 2
    s_cbranch_scc1 L_burst
    s_cmp_lt_u32 s52, 2
    s_cbranch_scc0 L_burst
    s_lshr_b32 s69, s2, 3
    s_lshl_b32 s69, s69, 2
    v_min_u32 v6, 11, v7
    v_add_u32 v6, s69, v6
    v_and_b32 v6, 0x7f, v6
    v_lshlrev_b32 v6, 7, v6
    buffer_load_dword v126, v6, s[20:23], 0 offen
    s_cmp_eq_u32 s56, 3
    s_cbranch_scc0 L_nogate
    s_cmp_eq_u32 s52, 0
    s_cbranch_scc0 L_nogate
    s_lshl_b32 s69, s55, 7
    v_add_u32 v6, s69, v1
    s_movk_i32 m0, 28992
    v_and_b32 v6, 0x3ff, v6
    buffer_load_dwordx4 v6, s[28:31], 0 offen lds
L_nogate:
L_burst:
    s_add_u32 s61, s55, 1
    s_and_b32 s61, s61, 7
    s_lshl_b32 s69, s61, 7
    s_add_u32 m0, s59, 40960
    s_add_u32 s69, s69, s76
    buffer_load_dwordx4 v3, s[8:11], s69 offen lds
    s_mov_b32 s26, 10485760
    s_mov_b32 s27, 0x20000
    s_cmp_eq_u32 s52, 4
    s_cselect_b32 s89, s72, 2
    s_cmp_lt_u32 s89, 2
    s_cselect_b32 s89, 1, 0
    s_cbranch_scc0 L_noclr
    v_mov_b32 v64, -1
    v_mov_b32 v65, -1
    v_mov_b32 v66, -1
    v_mov_b32 v67, -1
    s_mul_i32 s69, s53, 4352
    s_lshl_b32 s70, s72, 10
    s_add_u32 s70, s70, s69
    buffer_store_dwordx4 v[64:67], v1, s[24:27], s70 offen sc1
    buffer_store_dwordx4 v[64:67], v1, s[24:27], s70 offen offset:2176 sc1
    v_mov_b32 v68, 0
    v_mov_b32 v69, 0
    v_mov_b32 v70, 0
    v_mov_b32 v71, 0
    s_lshl1_add_u32 s70, s53, s72
    s_lshl_b32 s70, s70, 12
    s_add_u32 s70, s70, 262144
    buffer_store_dwordx4 v[68:71], v1, s[24:27], s70 offen sc1
    buffer_store_dwordx4 v[68:71], v1, s[24:27], s70 offen offset:1024 sc1
    buffer_store_dwordx4 v[68:71], v1, s[24:27], s70 offen offset:2048 sc1
    buffer_store_dwordx4 v[68:71], v1, s[24:27], s70 offen offset:3072 sc1
    s_mov_b64 exec, 0xffff
    s_cmp_eq_u32 s72, 0
    s_cbranch_scc0 L_clrV
    s_lshl_b32 s70, s53, 8
    s_add_u32 s70, s70, 147456
    buffer_store_dwordx4 v[64:67], v1, s[24:27], s70 offen sc1
    s_branch L_clrd
L_clrV:
    v_and_b32 v73, 0x70, v1
    v_cmp_eq_u32 s[74:75], 0, v73
    v_mov_b32 v72, 0x3f803f80
    s_nop 0
    v_cndmask_b32 v72, 0, v72, s[74:75]
    v_mov_b32 v73, v72
    v_mov_b32 v74, v72
    v_mov_b32 v75, v72
    v_lshrrev_b32 v76, 7, v1
    v_mul_u32_u24 v76, 2048, v76
    v_add_u32 v76, v76, v1
    buffer_store_dwordx4 v[72:75], v76, s[24:27], s69 offen offset:2048 sc1
L_clrd:
    s_mov_b64 exec, -1
L_noclr:
    s_load_dwordx2 s[12:13], s[0:1], 48
    s_load_dwordx2 s[48:49], s[0:1], 88
    s_load_dwordx2 s[36:37], s[0:1], 32
    s_load_dwordx2 s[40:41], s[0:1], 64
    s_load_dwordx2 s[44:45], s[0:1], 80
    v_lshrrev_b32 v5, 2, v0
    s_lshl_b32 s77, s54, 7
    v_and_b32 v5, 4, v5
    s_mov_b32 s60, s55
    v_xor_b32 v5, v5, v2
    s_mov_b32 s18, 0x80000
    v_lshl_add_u32 v4, v5, 4, v4
    s_mov_b32 s19, 0x20000
    v_lshrrev_b32 v6, 3, v0
    v_mul_u32_u24 v6, 3072, v6
    v_lshl_add_u32 v5, v5, 4, v6
    v_mov_b32 v2, v7
    s_add_u32 s62, s55, 2
    s_and_b32 s62, s62, 7
    s_add_u32 s63, s55, 3
    s_and_b32 s63, s63, 7
    s_add_u32 s64, s55, 4
    s_and_b32 s64, s64, 7
    s_add_u32 s65, s55, 5
    s_and_b32 s65, s65, 7
    s_add_u32 s66, s55, 6
    s_and_b32 s66, s66, 7
    s_add_u32 s67, s55, 7
    s_and_b32 s67, s67, 7
    s_mov_b32 s14, 0x180000
    s_mov_b32 s15, 0x20000
    s_mov_b32 s50, 0x100
    s_mov_b32 s51, 0x20000
    s_mov_b32 s38, 0x80000
    s_mov_b32 s39, 0x20000
    s_mov_b32 s42, 0x80000
    s_mov_b32 s43, 0x20000
    s_mov_b32 s46, 0x200000
    s_mov_b32 s47, 0x20000
    s_mov_b32 s68, 0x80000
    s_and_b32 s57, s52, 1
    s_bfe_u32 s58, s52, 0x10001
    v_and_b32 v6, 31, v2
    v_lshrrev_b32 v8, 5, v2
    v_bfe_u32 v9, v2, 1, 3
    v_xor_b32 v9, v9, v8
    s_lshl_b32 s69, s57, 12
    s_add_u32 s69, s69, 32768
    v_lshlrev_b32 v10, 7, v6
    v_add_u32 v10, s69, v10
    v_lshl_add_u32 v48, v9, 4, v10
    v_xor_b32 v49, 32, v48
    v_xor_b32 v50, 64, v48
    v_xor_b32 v51, 0x60, v48
    v_bfe_u32 v9, v2, 2, 2
    v_and_b32 v10, 3, v2
    s_waitcnt lgkmcnt(0)
    s_cmp_ge_u32 s52, 4
    s_cbranch_scc1 L_H
    s_setprio 1
    s_lshl_b32 s3, s57, 12
    v_lshrrev_b32 v16, 3, v2
    v_and_b32 v17, 7, v2
    v_lshrrev_b32 v18, 4, v2
    v_xor_b32 v18, v18, v17
    v_lshrrev_b32 v19, 2, v2
    v_and_b32 v19, 4, v19
    v_xor_b32 v19, v19, v17
    s_lshl_b32 s69, s57, 5
    v_add_u32 v16, s69, v16
    v_lshlrev_b32 v17, 10, v16
    v_lshl_add_u32 v24, v18, 4, v17
    v_lshl_add_u32 v28, v19, 4, v17
    v_mul_u32_u24 v17, 3072, v16
    v_lshl_add_u32 v32, v19, 4, v17
    s_sub_u32 s69, s73, s54
    s_add_u32 s69, s69, 8
    s_lshl_b32 s69, s69, 7
    v_add_u32 v32, s69, v32
    v_add_u32 v25, 7168, v24
    v_add_u32 v29, 7168, v28
    v_add_u32 v33, 23552, v32
    v_add_u32 v26, 14336, v24
    v_add_u32 v30, 14336, v28
    v_add_u32 v34, 47104, v32
    v_add_u32 v27, 21504, v24
    v_add_u32 v31, 21504, v28
    v_add_u32 v35, 70656, v32
    v_xor_b32 v25, 64, v25
    v_xor_b32 v27, 64, v27
    s_cmp_lt_u32 s52, 2
    s_cbranch_scc1 L_nold
    s_cmp_lt_u32 s72, 2
    s_cbranch_scc1 L_ldp
    s_lshl_b32 s69, s60, 16
    s_add_u32 m0, s3, 98304
    s_add_u32 s69, s69, s77
    buffer_load_dwordx4 v28, s[16:19], s69 offen offset:0 lds
    buffer_load_dwordx4 v29, s[16:19], s69 offen offset:1024 lds
    buffer_load_dwordx4 v30, s[16:19], s69 offen offset:2048 lds
    buffer_load_dwordx4 v31, s[16:19], s69 offen offset:3072 lds
    s_lshl_b32 s69, s61, 16
    s_add_u32 m0, s3, 106496
    s_add_u32 s69, s69, s77
    buffer_load_dwordx4 v28, s[16:19], s69 offen offset:0 lds
    buffer_load_dwordx4 v29, s[16:19], s69 offen offset:1024 lds
    buffer_load_dwordx4 v30, s[16:19], s69 offen offset:2048 lds
    buffer_load_dwordx4 v31, s[16:19], s69 offen offset:3072 lds
    s_branch L_nold
L_ldp:
    s_lshl_b32 s69, s62, 7
    s_add_u32 m0, s3, 49152
    s_add_u32 s69, s69, s76
    buffer_load_dwordx4 v24, s[8:11], s69 offen offset:0 lds
    buffer_load_dwordx4 v25, s[8:11], s69 offen offset:1024 lds
    buffer_load_dwordx4 v26, s[8:11], s69 offen offset:2048 lds
    buffer_load_dwordx4 v27, s[8:11], s69 offen offset:3072 lds
    s_lshl_b32 s69, s63, 7
    s_add_u32 m0, s3, 57344
    s_add_u32 s69, s69, s76
    buffer_load_dwordx4 v24, s[8:11], s69 offen offset:0 lds
    buffer_load_dwordx4 v25, s[8:11], s69 offen offset:1024 lds
    buffer_load_dwordx4 v26, s[8:11], s69 offen offset:2048 lds
    buffer_load_dwordx4 v27, s[8:11], s69 offen offset:3072 lds
L_nold:
    v_and_b32 v16, 15, v6
    v_lshl_add_u32 v17, v8, 4, v16
    v_lshlrev_b32 v17, 4, v17
    v_cmp_gt_u32 s[92:93], 16, v6
    v_min_u32 v18, 17, v6
    v_lshlrev_b32 v18, 4, v18
    v_add_u32 v4, 768, v18
    v_add_u32 v5, 256, v18
    s_lshr_b32 s69, s2, 3
    s_mul_i32 s70, s52, 14
    s_add_u32 s69, s69, s70
    s_sub_u32 s69, s69, 2
    v_cndmask_b32 v4, v4, v17, s[92:93]
    v_cndmask_b32 v5, v5, v17, s[92:93]
    v_cmp_gt_u32 s[90:91], 2, v16
    v_add_u32 v17, s69, v16
    v_subrev_u32 v18, 56, v17
    v_min_u32 v17, v17, v18
    v_add_u32 v17, 8, v17
    s_lshl_b32 s70, s52, 1
    v_add_u32 v16, s70, v16
    v_cndmask_b32 v16, v17, v16, s[90:91]
    s_lshl_b32 s70, s2, 3
    v_add_u32 v16, s70, v16
    v_and_b32 v16, 63, v16
    v_mul_u32_u24 v16, 2176, v16
    v_lshrrev_b32 v17, 4, v6
    v_lshl_add_u32 v0, v17, 10, v16
    v_mov_b32 v60, 0
    v_mov_b32 v61, 0
    v_add_u32 v3, 18432, v1
    s_mul_i32 s73, s52, 2304
    v_lshlrev_b32 v62, 2, v2
    v_add_u32 v62, s73, v62
    v_readlane_b32 s70, v16, 0
    s_add_u32 s28, s24, s70
    s_addc_u32 s29, s25, 0
    v_readlane_b32 s70, v16, 1
    s_add_u32 s30, s24, s70
    s_addc_u32 s31, s25, 0
    v_readlane_b32 s70, v16, 2
    s_add_u32 s32, s24, s70
    s_addc_u32 s33, s25, 0
    v_readlane_b32 s70, v16, 3
    s_add_u32 s34, s24, s70
    s_addc_u32 s35, s25, 0
    v_readlane_b32 s70, v16, 4
    s_add_u32 s36, s24, s70
    s_addc_u32 s37, s25, 0
    v_readlane_b32 s70, v16, 5
    s_add_u32 s38, s24, s70
    s_addc_u32 s39, s25, 0
    v_readlane_b32 s70, v16, 6
    s_add_u32 s40, s24, s70
    s_addc_u32 s41, s25, 0
    v_readlane_b32 s70, v16, 7
    s_add_u32 s42, s24, s70
    s_addc_u32 s43, s25, 0
    v_readlane_b32 s70, v16, 8
    s_add_u32 s44, s24, s70
    s_addc_u32 s45, s25, 0
    v_readlane_b32 s70, v16, 9
    s_add_u32 s46, s24, s70
    s_addc_u32 s47, s25, 0
    v_readlane_b32 s70, v16, 10
    s_add_u32 s78, s24, s70
    s_addc_u32 s79, s25, 0
    v_readlane_b32 s70, v16, 11
    s_add_u32 s80, s24, s70
    s_addc_u32 s81, s25, 0
    v_readlane_b32 s70, v16, 12
    s_add_u32 s82, s24, s70
    s_addc_u32 s83, s25, 0
    v_readlane_b32 s70, v16, 13
    s_add_u32 s84, s24, s70
    s_addc_u32 s85, s25, 0
    v_readlane_b32 s70, v16, 14
    s_add_u32 s86, s24, s70
    s_addc_u32 s87, s25, 0
    v_readlane_b32 s70, v16, 15
    s_add_u32 s88, s24, s70
    s_addc_u32 s89, s25, 0
    s_cmp_ge_u32 s52, 2
    s_cbranch_scc1 L_loader
    v_lshrrev_b32 v17, 4, v2
    v_lshl_add_u32 v20, v17, 3, v9
    v_lshlrev_b32 v20, 5, v20
    v_lshl_add_u32 v20, v10, 3, v20
    v_lshlrev_b32 v21, 4, v17
    v_bfe_u32 v18, v2, 1, 3
    v_xor_b32 v18, v18, v17
    v_and_b32 v19, 15, v2
    v_lshlrev_b32 v19, 7, v19
    v_lshl_add_u32 v18, v18, 4, v19
    s_lshl_b32 s69, s57, 12
    s_add_u32 s69, s69, 32768
    v_add_u32 v18, s69, v18
    v_xor_b32 v19, 64, v18
    v_lshlrev_b32 v23, 2, v6
    s_lshl_b32 s70, s57, 7
    v_add_u32 v23, s70, v23
    s_lshl1_add_u32 s62, s53, s57
    s_mul_i32 s63, s62, 2176
    s_cmp_eq_u32 s56, 1
    s_cbranch_scc1 L_jobK
    s_cmp_eq_u32 s56, 2
    s_cbranch_scc1 L_jobV
    s_cmp_eq_u32 s56, 3
    s_cbranch_scc1 L_jobG
    s_waitcnt vmcnt(0)
    s_barrier
    s_barrier
    s_barrier
    s_barrier
    s_barrier
    s_branch L_jobdone
L_loader:
    s_cmp_lt_u32 s72, 2
    s_cbranch_scc1 L_loaderP
    s_lshl_b32 s69, s62, 7
    s_add_u32 m0, s3, 49152
    s_add_u32 s69, s69, s76
    buffer_load_dwordx4 v24, s[8:11], s69 offen offset:0 lds
    buffer_load_dwordx4 v25, s[8:11], s69 offen offset:1024 lds
    buffer_load_dwordx4 v26, s[8:11], s69 offen offset:2048 lds
    buffer_load_dwordx4 v27, s[8:11], s69 offen offset:3072 lds
    s_lshl_b32 s69, s63, 7
    s_add_u32 m0, s3, 57344
    s_add_u32 s69, s69, s76
    buffer_load_dwordx4 v24, s[8:11], s69 offen offset:0 lds
    buffer_load_dwordx4 v25, s[8:11], s69 offen offset:1024 lds
    buffer_load_dwordx4 v26, s[8:11], s69 offen offset:2048 lds
    buffer_load_dwordx4 v27, s[8:11], s69 offen offset:3072 lds
    s_lshl_b32 s69, s64, 7
    s_add_u32 m0, s3, 65536
    s_add_u32 s69, s69, s76
    buffer_load_dwordx4 v24, s[8:11], s69 offen offset:0 lds
    buffer_load_dwordx4 v25, s[8:11], s69 offen offset:1024 lds
    buffer_load_dwordx4 v26, s[8:11], s69 offen offset:2048 lds
    buffer_load_dwordx4 v27, s[8:11], s69 offen offset:3072 lds
    s_waitcnt vmcnt(12)
    s_barrier
    s_lshl_b32 s69, s65, 7
    s_add_u32 m0, s3, 73728
    s_add_u32 s69, s69, s76
    buffer_load_dwordx4 v24, s[8:11], s69 offen offset:0 lds
    buffer_load_dwordx4 v25, s[8:11], s69 offen offset:1024 lds
    buffer_load_dwordx4 v26, s[8:11], s69 offen offset:2048 lds
    buffer_load_dwordx4 v27, s[8:11], s69 offen offset:3072 lds
    s_lshl_b32 s69, s66, 7
    s_add_u32 m0, s3, 81920
    s_add_u32 s69, s69, s76
    buffer_load_dwordx4 v24, s[8:11], s69 offen offset:0 lds
    buffer_load_dwordx4 v25, s[8:11], s69 offen offset:1024 lds
    buffer_load_dwordx4 v26, s[8:11], s69 offen offset:2048 lds
    buffer_load_dwordx4 v27, s[8:11], s69 offen offset:3072 lds
    s_waitcnt vmcnt(12)
    s_barrier
    s_lshl_b32 s69, s67, 7
    s_add_u32 m0, s3, 90112
    s_add_u32 s69, s69, s76
    buffer_load_dwordx4 v24, s[8:11], s69 offen offset:0 lds
    buffer_load_dwordx4 v25, s[8:11], s69 offen offset:1024 lds
    buffer_load_dwordx4 v26, s[8:11], s69 offen offset:2048 lds
    buffer_load_dwordx4 v27, s[8:11], s69 offen offset:3072 lds
    s_lshl_b32 s69, s62, 16
    s_add_u32 m0, s3, 114688
    s_add_u32 s69, s69, s77
    buffer_load_dwordx4 v28, s[16:19], s69 offen offset:0 lds
    buffer_load_dwordx4 v29, s[16:19], s69 offen offset:1024 lds
    buffer_load_dwordx4 v30, s[16:19], s69 offen offset:2048 lds
    buffer_load_dwordx4 v31, s[16:19], s69 offen offset:3072 lds
    s_waitcnt vmcnt(12)
    s_barrier
    s_lshl_b32 s69, s63, 16
    s_add_u32 m0, s3, 122880
    s_add_u32 s69, s69, s77
    buffer_load_dwordx4 v28, s[16:19], s69 offen offset:0 lds
    buffer_load_dwordx4 v29, s[16:19], s69 offen offset:1024 lds
    buffer_load_dwordx4 v30, s[16:19], s69 offen offset:2048 lds
    buffer_load_dwordx4 v31, s[16:19], s69 offen offset:3072 lds
    s_lshl_b32 s69, s64, 16
    s_add_u32 m0, s3, 131072
    s_add_u32 s69, s69, s77
    buffer_load_dwordx4 v28, s[16:19], s69 offen offset:0 lds
    buffer_load_dwordx4 v29, s[16:19], s69 offen offset:1024 lds
    buffer_load_dwordx4 v30, s[16:19], s69 offen offset:2048 lds
    buffer_load_dwordx4 v31, s[16:19], s69 offen offset:3072 lds
    s_waitcnt vmcnt(12)
    s_barrier
    s_lshl_b32 s69, s65, 16
    s_add_u32 m0, s3, 139264
    s_add_u32 s69, s69, s77
    buffer_load_dwordx4 v28, s[16:19], s69 offen offset:0 lds
    buffer_load_dwordx4 v29, s[16:19], s69 offen offset:1024 lds
    buffer_load_dwordx4 v30, s[16:19], s69 offen offset:2048 lds
    buffer_load_dwordx4 v31, s[16:19], s69 offen offset:3072 lds
    s_barrier
    s_lshl_b32 s69, s66, 16
    s_add_u32 m0, s3, 147456
    s_add_u32 s69, s69, s77
    buffer_load_dwordx4 v28, s[16:19], s69 offen offset:0 lds
    buffer_load_dwordx4 v29, s[16:19], s69 offen offset:1024 lds
    buffer_load_dwordx4 v30, s[16:19], s69 offen offset:2048 lds
    buffer_load_dwordx4 v31, s[16:19], s69 offen offset:3072 lds
    s_lshl_b32 s69, s67, 16
    s_add_u32 m0, s3, 155648
    s_add_u32 s69, s69, s77
    buffer_load_dwordx4 v28, s[16:19], s69 offen offset:0 lds
    buffer_load_dwordx4 v29, s[16:19], s69 offen offset:1024 lds
    buffer_load_dwordx4 v30, s[16:19], s69 offen offset:2048 lds
    buffer_load_dwordx4 v31, s[16:19], s69 offen offset:3072 lds
L_loader2:
    s_waitcnt vmcnt(16)
    s_barrier
    s_mul_i32 s69, s60, 196608
    s_add_u32 m0, s3, 32768
    s_add_u32 s69, s69, s77
    buffer_load_dwordx4 v32, s[12:15], s69 offen offset:0 lds
    buffer_load_dwordx4 v33, s[12:15], s69 offen offset:1024 lds
    buffer_load_dwordx4 v34, s[12:15], s69 offen offset:2048 lds
    buffer_load_dwordx4 v35, s[12:15], s69 offen offset:3072 lds
    s_mul_i32 s69, s61, 196608
    s_add_u32 m0, s3, 40960
    s_add_u32 s69, s69, s77
    buffer_load_dwordx4 v32, s[12:15], s69 offen offset:0 lds
    buffer_load_dwordx4 v33, s[12:15], s69 offen offset:1024 lds
    buffer_load_dwordx4 v34, s[12:15], s69 offen offset:2048 lds
    buffer_load_dwordx4 v35, s[12:15], s69 offen offset:3072 lds
    s_waitcnt vmcnt(16)
    s_barrier
    s_mul_i32 s69, s62, 196608
    s_add_u32 m0, s3, 49152
    s_add_u32 s69, s69, s77
    buffer_load_dwordx4 v32, s[12:15], s69 offen offset:0 lds
    buffer_load_dwordx4 v33, s[12:15], s69 offen offset:1024 lds
    buffer_load_dwordx4 v34, s[12:15], s69 offen offset:2048 lds
    buffer_load_dwordx4 v35, s[12:15], s69 offen offset:3072 lds
    s_mul_i32 s69, s63, 196608
    s_add_u32 m0, s3, 57344
    s_add_u32 s69, s69, s77
    buffer_load_dwordx4 v32, s[12:15], s69 offen offset:0 lds
    buffer_load_dwordx4 v33, s[12:15], s69 offen offset:1024 lds
    buffer_load_dwordx4 v34, s[12:15], s69 offen offset:2048 lds
    buffer_load_dwordx4 v35, s[12:15], s69 offen offset:3072 lds
    s_waitcnt vmcnt(16)
    s_barrier
    s_mul_i32 s69, s64, 196608
    s_add_u32 m0, s3, 65536
    s_add_u32 s69, s69, s77
    buffer_load_dwordx4 v32, s[12:15], s69 offen offset:0 lds
    buffer_load_dwordx4 v33, s[12:15], s69 offen offset:1024 lds
    buffer_load_dwordx4 v34, s[12:15], s69 offen offset:2048 lds
    buffer_load_dwordx4 v35, s[12:15], s69 offen offset:3072 lds
    s_mul_i32 s69, s65, 196608
    s_add_u32 m0, s3, 73728
    s_add_u32 s69, s69, s77
    buffer_load_dwordx4 v32, s[12:15], s69 offen offset:0 lds
    buffer_load_dwordx4 v33, s[12:15], s69 offen offset:1024 lds
    buffer_load_dwordx4 v34, s[12:15], s69 offen offset:2048 lds
    buffer_load_dwordx4 v35, s[12:15], s69 offen offset:3072 lds
    s_mul_i32 s69, s66, 196608
    s_add_u32 m0, s3, 81920
    s_add_u32 s69, s69, s77
    buffer_load_dwordx4 v32, s[12:15], s69 offen offset:0 lds
    buffer_load_dwordx4 v33, s[12:15], s69 offen offset:1024 lds
    buffer_load_dwordx4 v34, s[12:15], s69 offen offset:2048 lds
    buffer_load_dwordx4 v35, s[12:15], s69 offen offset:3072 lds
    s_mul_i32 s69, s67, 196608
    s_add_u32 m0, s3, 90112
    s_add_u32 s69, s69, s77
    buffer_load_dwordx4 v32, s[12:15], s69 offen offset:0 lds
    buffer_load_dwordx4 v33, s[12:15], s69 offen offset:1024 lds
    buffer_load_dwordx4 v34, s[12:15], s69 offen offset:2048 lds
    buffer_load_dwordx4 v35, s[12:15], s69 offen offset:3072 lds
    s_waitcnt vmcnt(16)
    s_branch L_B9
.p2align 12
L_loaderP:
    s_lshl2_add_u32 s70, s57, 0
    s_add_u32 s69, s70, s55
    s_and_b32 s69, s69, 7
    s_lshl_b32 m0, s70, 11
    s_lshl_b32 s69, s69, 11
    buffer_load_dwordx4 v1, s[20:23], s69 offen lds
    buffer_load_dwordx4 v1, s[20:23], s69 offen offset:1024 lds
    s_lshl2_add_u32 s70, s57, 1
    s_add_u32 s69, s70, s55
    s_and_b32 s69, s69, 7
    s_lshl_b32 m0, s70, 11
    s_lshl_b32 s69, s69, 11
    buffer_load_dwordx4 v1, s[20:23], s69 offen lds
    buffer_load_dwordx4 v1, s[20:23], s69 offen offset:1024 lds
    s_lshl2_add_u32 s70, s57, 2
    s_add_u32 s69, s70, s55
    s_and_b32 s69, s69, 7
    s_lshl_b32 m0, s70, 11
    s_lshl_b32 s69, s69, 11
    buffer_load_dwordx4 v1, s[20:23], s69 offen lds
    buffer_load_dwordx4 v1, s[20:23], s69 offen offset:1024 lds
    s_lshl2_add_u32 s70, s57, 3
    s_add_u32 s69, s70, s55
    s_and_b32 s69, s69, 7
    s_lshl_b32 m0, s70, 11
    s_lshl_b32 s69, s69, 11
    buffer_load_dwordx4 v1, s[20:23], s69 offen lds
    buffer_load_dwordx4 v1, s[20:23], s69 offen offset:1024 lds
    s_waitcnt vmcnt(16)
    s_barrier
    s_lshl_b32 s69, s64, 7
    s_add_u32 m0, s3, 65536
    s_add_u32 s69, s69, s76
    buffer_load_dwordx4 v24, s[8:11], s69 offen offset:0 lds
    buffer_load_dwordx4 v25, s[8:11], s69 offen offset:1024 lds
    buffer_load_dwordx4 v26, s[8:11], s69 offen offset:2048 lds
    buffer_load_dwordx4 v27, s[8:11], s69 offen offset:3072 lds
    s_lshl_b32 s69, s65, 7
    s_add_u32 m0, s3, 73728
    s_add_u32 s69, s69, s76
    buffer_load_dwordx4 v24, s[8:11], s69 offen offset:0 lds
    buffer_load_dwordx4 v25, s[8:11], s69 offen offset:1024 lds
    buffer_load_dwordx4 v26, s[8:11], s69 offen offset:2048 lds
    buffer_load_dwordx4 v27, s[8:11], s69 offen offset:3072 lds
    s_lshl_b32 s69, s66, 7
    s_add_u32 m0, s3, 81920
    s_add_u32 s69, s69, s76
    buffer_load_dwordx4 v24, s[8:11], s69 offen offset:0 lds
    buffer_load_dwordx4 v25, s[8:11], s69 offen offset:1024 lds
    buffer_load_dwordx4 v26, s[8:11], s69 offen offset:2048 lds
    buffer_load_dwordx4 v27, s[8:11], s69 offen offset:3072 lds
    s_waitcnt vmcnt(12)
    s_barrier
    s_lshl_b32 s69, s67, 7
    s_add_u32 m0, s3, 90112
    s_add_u32 s69, s69, s76
    buffer_load_dwordx4 v24, s[8:11], s69 offen offset:0 lds
    buffer_load_dwordx4 v25, s[8:11], s69 offen offset:1024 lds
    buffer_load_dwordx4 v26, s[8:11], s69 offen offset:2048 lds
    buffer_load_dwordx4 v27, s[8:11], s69 offen offset:3072 lds
    s_lshl_b32 s69, s62, 16
    s_add_u32 m0, s3, 114688
    s_add_u32 s69, s69, s77
    buffer_load_dwordx4 v28, s[16:19], s69 offen offset:0 lds
    buffer_load_dwordx4 v29, s[16:19], s69 offen offset:1024 lds
    buffer_load_dwordx4 v30, s[16:19], s69 offen offset:2048 lds
    buffer_load_dwordx4 v31, s[16:19], s69 offen offset:3072 lds
    s_waitcnt vmcnt(12)
    s_barrier
    s_lshl_b32 s69, s63, 16
    s_add_u32 m0, s3, 122880
    s_add_u32 s69, s69, s77
    buffer_load_dwordx4 v28, s[16:19], s69 offen offset:0 lds
    buffer_load_dwordx4 v29, s[16:19], s69 offen offset:1024 lds
    buffer_load_dwordx4 v30, s[16:19], s69 offen offset:2048 lds
    buffer_load_dwordx4 v31, s[16:19], s69 offen offset:3072 lds
    s_lshl_b32 s69, s64, 16
    s_add_u32 m0, s3, 131072
    s_add_u32 s69, s69, s77
    buffer_load_dwordx4 v28, s[16:19], s69 offen offset:0 lds
    buffer_load_dwordx4 v29, s[16:19], s69 offen offset:1024 lds
    buffer_load_dwordx4 v30, s[16:19], s69 offen offset:2048 lds
    buffer_load_dwordx4 v31, s[16:19], s69 offen offset:3072 lds
    s_waitcnt vmcnt(12)
    s_barrier
    s_lshl_b32 s69, s65, 16
    s_add_u32 m0, s3, 139264
    s_add_u32 s69, s69, s77
    buffer_load_dwordx4 v28, s[16:19], s69 offen offset:0 lds
    buffer_load_dwordx4 v29, s[16:19], s69 offen offset:1024 lds
    buffer_load_dwordx4 v30, s[16:19], s69 offen offset:2048 lds
    buffer_load_dwordx4 v31, s[16:19], s69 offen offset:3072 lds
    s_lshl_b32 s69, s66, 16
    s_add_u32 m0, s3, 147456
    s_add_u32 s69, s69, s77
    buffer_load_dwordx4 v28, s[16:19], s69 offen offset:0 lds
    buffer_load_dwordx4 v29, s[16:19], s69 offen offset:1024 lds
    buffer_load_dwordx4 v30, s[16:19], s69 offen offset:2048 lds
    buffer_load_dwordx4 v31, s[16:19], s69 offen offset:3072 lds
    s_lshl_b32 s69, s67, 16
    s_add_u32 m0, s3, 155648
    s_add_u32 s69, s69, s77
    buffer_load_dwordx4 v28, s[16:19], s69 offen offset:0 lds
    buffer_load_dwordx4 v29, s[16:19], s69 offen offset:1024 lds
    buffer_load_dwordx4 v30, s[16:19], s69 offen offset:2048 lds
    buffer_load_dwordx4 v31, s[16:19], s69 offen offset:3072 lds
    s_waitcnt vmcnt(16)
    s_barrier
    s_lshl_b32 s69, s60, 16
    s_add_u32 m0, s3, 98304
    s_add_u32 s69, s69, s77
    buffer_load_dwordx4 v28, s[16:19], s69 offen offset:0 lds
    buffer_load_dwordx4 v29, s[16:19], s69 offen offset:1024 lds
    buffer_load_dwordx4 v30, s[16:19], s69 offen offset:2048 lds
    buffer_load_dwordx4 v31, s[16:19], s69 offen offset:3072 lds
    s_lshl_b32 s69, s61, 16
    s_add_u32 m0, s3, 106496
    s_add_u32 s69, s69, s77
    buffer_load_dwordx4 v28, s[16:19], s69 offen offset:0 lds
    buffer_load_dwordx4 v29, s[16:19], s69 offen offset:1024 lds
    buffer_load_dwordx4 v30, s[16:19], s69 offen offset:2048 lds
    buffer_load_dwordx4 v31, s[16:19], s69 offen offset:3072 lds
    s_branch L_loader2
L_jobK:
    s_setprio 3
    v_and_b32 v16, 3, v2
    v_bfe_u32 v17, v2, 2, 1
    v_lshl_add_u32 v16, v17, 3, v16
    v_bfe_u32 v17, v2, 3, 1
    v_lshl_add_u32 v16, v17, 2, v16
    v_lshl_add_u32 v16, v8, 4, v16
    v_bfe_u32 v17, v2, 4, 1
    v_lshl_add_u32 v16, v17, 5, v16
    v_lshlrev_b32 v16, 4, v16
    s_waitcnt vmcnt(0)
    s_barrier
    ds_read_b128 a[0:3], v18 offset:0
    ds_read_b128 a[4:7], v18 offset:2048
    ds_read_b128 a[8:11], v19 offset:0
    ds_read_b128 a[12:15], v19 offset:2048
    ds_read_b128 a[16:19], v18 offset:8192
    ds_read_b128 a[20:23], v18 offset:10240
    ds_read_b128 a[24:27], v19 offset:8192
    ds_read_b128 a[28:31], v19 offset:10240
    s_barrier
    ds_read_b64_tr_b16 a[64:65], v20 offset:0
    ds_read_b64_tr_b16 a[66:67], v20 offset:128
    ds_read_b64_tr_b16 a[68:69], v20 offset:1024
    ds_read_b64_tr_b16 a[70:71], v20 offset:1152
    ds_read_b64_tr_b16 a[72:73], v20 offset:2048
    ds_read_b64_tr_b16 a[74:75], v20 offset:2176
    ds_read_b64_tr_b16 a[76:77], v20 offset:3072
    ds_read_b64_tr_b16 a[78:79], v20 offset:3200
    ds_read_b64_tr_b16 a[80:81], v20 offset:4096
    ds_read_b64_tr_b16 a[82:83], v20 offset:4224
    ds_read_b64_tr_b16 a[84:85], v20 offset:5120
    ds_read_b64_tr_b16 a[86:87], v20 offset:5248
    ds_read_b64_tr_b16 a[88:89], v20 offset:6144
    ds_read_b64_tr_b16 a[90:91], v20 offset:6272
    ds_read_b64_tr_b16 a[92:93], v20 offset:7168
    ds_read_b64_tr_b16 a[94:95], v20 offset:7296
    ds_read_b128 a[32:35], v18 offset:16384
    ds_read_b128 a[36:39], v18 offset:18432
    s_waitcnt lgkmcnt(15)
    v_mfma_f32_16x16x32_bf16 v[24:27], a[64:67], a[0:3], 0
    v_mfma_f32_16x16x32_bf16 v[28:31], a[64:67], a[4:7], 0
    ds_read_b128 a[40:43], v19 offset:16384
    ds_read_b128 a[44:47], v19 offset:18432
    s_waitcnt lgkmcnt(15)
    v_mfma_f32_16x16x32_bf16 v[24:27], a[68:71], a[8:11], v[24:27]
    v_mfma_f32_16x16x32_bf16 v[28:31], a[68:71], a[12:15], v[28:31]
    ds_read_b128 a[48:51], v18 offset:24576
    ds_read_b128 a[52:55], v18 offset:26624
    s_waitcnt lgkmcnt(15)
    v_mfma_f32_16x16x32_bf16 v[24:27], a[72:75], a[16:19], v[24:27]
    v_mfma_f32_16x16x32_bf16 v[28:31], a[72:75], a[20:23], v[28:31]
    ds_read_b128 a[56:59], v19 offset:24576
    ds_read_b128 a[60:63], v19 offset:26624
    s_waitcnt lgkmcnt(15)
    v_mfma_f32_16x16x32_bf16 v[24:27], a[76:79], a[24:27], v[24:27]
    v_mfma_f32_16x16x32_bf16 v[28:31], a[76:79], a[28:31], v[28:31]
    s_barrier
    ds_read_b128 v[64:67], v18 offset:32768
    ds_read_b128 v[68:71], v18 offset:34816
    ds_read_b64_tr_b16 a[96:97], v20 offset:8192
    ds_read_b64_tr_b16 a[98:99], v20 offset:8320
    ds_read_b64_tr_b16 a[100:101], v20 offset:9216
    ds_read_b64_tr_b16 a[102:103], v20 offset:9344
    s_waitcnt lgkmcnt(12)
    v_mfma_f32_16x16x32_bf16 v[24:27], a[80:83], a[32:35], v[24:27]
    v_mfma_f32_16x16x32_bf16 v[28:31], a[80:83], a[36:39], v[28:31]
    ds_read_b128 v[72:75], v19 offset:32768
    ds_read_b128 v[76:79], v19 offset:34816
    ds_read_b64_tr_b16 a[104:105], v20 offset:10240
    ds_read_b64_tr_b16 a[106:107], v20 offset:10368
    ds_read_b64_tr_b16 a[108:109], v20 offset:11264
    ds_read_b64_tr_b16 a[110:111], v20 offset:11392
    s_waitcnt lgkmcnt(15)
    v_mfma_f32_16x16x32_bf16 v[24:27], a[84:87], a[40:43], v[24:27]
    v_mfma_f32_16x16x32_bf16 v[28:31], a[84:87], a[44:47], v[28:31]
    ds_read_b128 v[80:83], v18 offset:40960
    ds_read_b128 v[84:87], v18 offset:43008
    ds_read_b64_tr_b16 a[112:113], v20 offset:12288
    ds_read_b64_tr_b16 a[114:115], v20 offset:12416
    ds_read_b64_tr_b16 a[116:117], v20 offset:13312
    ds_read_b64_tr_b16 a[118:119], v20 offset:13440
    s_waitcnt lgkmcnt(15)
    v_mfma_f32_16x16x32_bf16 v[24:27], a[88:91], a[48:51], v[24:27]
    v_mfma_f32_16x16x32_bf16 v[28:31], a[88:91], a[52:55], v[28:31]
    ds_read_b128 v[88:91], v19 offset:40960
    ds_read_b128 v[92:95], v19 offset:43008
    ds_read_b64_tr_b16 a[120:121], v20 offset:14336
    ds_read_b64_tr_b16 a[122:123], v20 offset:14464
    ds_read_b64_tr_b16 a[124:125], v20 offset:15360
    ds_read_b64_tr_b16 a[126:127], v20 offset:15488
    s_waitcnt lgkmcnt(15)
    v_mfma_f32_16x16x32_bf16 v[24:27], a[92:95], a[56:59], v[24:27]
    v_mfma_f32_16x16x32_bf16 v[28:31], a[92:95], a[60:63], v[28:31]
    s_barrier
    ds_read_b128 v[96:99], v18 offset:49152
    ds_read_b128 v[100:103], v18 offset:51200
    s_waitcnt lgkmcnt(15)
    v_mfma_f32_16x16x32_bf16 v[24:27], a[96:99], v[64:67], v[24:27]
    v_mfma_f32_16x16x32_bf16 v[28:31], a[96:99], v[68:71], v[28:31]
    ds_read_b128 v[104:107], v19 offset:49152
    ds_read_b128 v[108:111], v19 offset:51200
    s_waitcnt lgkmcnt(15)
    v_mfma_f32_16x16x32_bf16 v[24:27], a[100:103], v[72:75], v[24:27]
    v_mfma_f32_16x16x32_bf16 v[28:31], a[100:103], v[76:79], v[28:31]
    ds_read_b128 v[112:115], v18 offset:57344
    ds_read_b128 v[116:119], v18 offset:59392
    s_waitcnt lgkmcnt(15)
    v_mfma_f32_16x16x32_bf16 v[24:27], a[104:107], v[80:83], v[24:27]
    v_mfma_f32_16x16x32_bf16 v[28:31], a[104:107], v[84:87], v[28:31]
    ds_read_b128 v[120:123], v19 offset:57344
    ds_read_b128 v[124:127], v19 offset:59392
    s_waitcnt lgkmcnt(12)
    v_mfma_f32_16x16x32_bf16 v[24:27], a[108:111], v[88:91], v[24:27]
    v_mfma_f32_16x16x32_bf16 v[28:31], a[108:111], v[92:95], v[28:31]
    s_waitcnt lgkmcnt(6)
    v_mfma_f32_16x16x32_bf16 v[24:27], a[112:115], v[96:99], v[24:27]
    v_mfma_f32_16x16x32_bf16 v[28:31], a[112:115], v[100:103], v[28:31]
    s_waitcnt lgkmcnt(4)
    v_mfma_f32_16x16x32_bf16 v[24:27], a[116:119], v[104:107], v[24:27]
    v_mfma_f32_16x16x32_bf16 v[28:31], a[116:119], v[108:111], v[28:31]
    s_waitcnt lgkmcnt(2)
    v_mfma_f32_16x16x32_bf16 v[24:27], a[120:123], v[112:115], v[24:27]
    v_mfma_f32_16x16x32_bf16 v[28:31], a[120:123], v[116:119], v[28:31]
    s_waitcnt lgkmcnt(0)
    v_mfma_f32_16x16x32_bf16 v[24:27], a[124:127], v[120:123], v[24:27]
    v_mfma_f32_16x16x32_bf16 v[28:31], a[124:127], v[124:127], v[28:31]
    s_nop 7
    v_mul_f32 v24, 0x3eb8aa3b, v24
    v_mul_f32 v25, 0x3eb8aa3b, v25
    v_mul_f32 v26, 0x3eb8aa3b, v26
    v_mul_f32 v27, 0x3eb8aa3b, v27
    v_mul_f32 v28, 0x3eb8aa3b, v28
    v_mul_f32 v29, 0x3eb8aa3b, v29
    v_mul_f32 v30, 0x3eb8aa3b, v30
    v_mul_f32 v31, 0x3eb8aa3b, v31
    v_cvt_pk_bf16_f32 v40, v24, v25
    v_cvt_pk_bf16_f32 v41, v26, v27
    v_cvt_pk_bf16_f32 v42, v28, v29
    v_cvt_pk_bf16_f32 v43, v30, v31
    s_nop 0
    v_permlane32_swap_b32 v40, v42
    v_permlane32_swap_b32 v41, v43
    buffer_store_dwordx4 v[40:43], v16, s[24:27], s63 offen sc1
    s_setprio 1
    s_barrier
    s_branch L_jobdone
L_jobV:
    s_setprio 3
    s_waitcnt vmcnt(0)
    s_barrier
    ds_read_b128 a[0:3], v18 offset:0
    ds_read_b128 a[4:7], v18 offset:2048
    ds_read_b128 a[8:11], v19 offset:0
    ds_read_b128 a[12:15], v19 offset:2048
    ds_read_b128 a[16:19], v18 offset:8192
    ds_read_b128 a[20:23], v18 offset:10240
    ds_read_b128 a[24:27], v19 offset:8192
    ds_read_b128 a[28:31], v19 offset:10240
    s_barrier
    ds_read_b64_tr_b16 a[64:65], v20 offset:0
    ds_read_b64_tr_b16 a[66:67], v20 offset:128
    ds_read_b64_tr_b16 a[68:69], v20 offset:1024
    ds_read_b64_tr_b16 a[70:71], v20 offset:1152
    ds_read_b64_tr_b16 a[72:73], v20 offset:2048
    ds_read_b64_tr_b16 a[74:75], v20 offset:2176
    ds_read_b64_tr_b16 a[76:77], v20 offset:3072
    ds_read_b64_tr_b16 a[78:79], v20 offset:3200
    ds_read_b64_tr_b16 a[80:81], v20 offset:4096
    ds_read_b64_tr_b16 a[82:83], v20 offset:4224
    ds_read_b64_tr_b16 a[84:85], v20 offset:5120
    ds_read_b64_tr_b16 a[86:87], v20 offset:5248
    ds_read_b64_tr_b16 a[88:89], v20 offset:6144
    ds_read_b64_tr_b16 a[90:91], v20 offset:6272
    ds_read_b64_tr_b16 a[92:93], v20 offset:7168
    ds_read_b64_tr_b16 a[94:95], v20 offset:7296
    ds_read_b128 a[32:35], v18 offset:16384
    ds_read_b128 a[36:39], v18 offset:18432
    s_waitcnt lgkmcnt(15)
    v_mfma_f32_16x16x32_bf16 v[24:27], a[0:3], a[64:67], 0
    v_mfma_f32_16x16x32_bf16 v[28:31], a[4:7], a[64:67], 0
    ds_read_b128 a[40:43], v19 offset:16384
    ds_read_b128 a[44:47], v19 offset:18432
    s_waitcnt lgkmcnt(15)
    v_mfma_f32_16x16x32_bf16 v[24:27], a[8:11], a[68:71], v[24:27]
    v_mfma_f32_16x16x32_bf16 v[28:31], a[12:15], a[68:71], v[28:31]
    ds_read_b128 a[48:51], v18 offset:24576
    ds_read_b128 a[52:55], v18 offset:26624
    s_waitcnt lgkmcnt(15)
    v_mfma_f32_16x16x32_bf16 v[24:27], a[16:19], a[72:75], v[24:27]
    v_mfma_f32_16x16x32_bf16 v[28:31], a[20:23], a[72:75], v[28:31]
    ds_read_b128 a[56:59], v19 offset:24576
    ds_read_b128 a[60:63], v19 offset:26624
    s_waitcnt lgkmcnt(15)
    v_mfma_f32_16x16x32_bf16 v[24:27], a[24:27], a[76:79], v[24:27]
    v_mfma_f32_16x16x32_bf16 v[28:31], a[28:31], a[76:79], v[28:31]
    s_barrier
    ds_read_b128 v[64:67], v18 offset:32768
    ds_read_b128 v[68:71], v18 offset:34816
    ds_read_b64_tr_b16 a[96:97], v20 offset:8192
    ds_read_b64_tr_b16 a[98:99], v20 offset:8320
    ds_read_b64_tr_b16 a[100:101], v20 offset:9216
    ds_read_b64_tr_b16 a[102:103], v20 offset:9344
    s_waitcnt lgkmcnt(12)
    v_mfma_f32_16x16x32_bf16 v[24:27], a[32:35], a[80:83], v[24:27]
    v_mfma_f32_16x16x32_bf16 v[28:31], a[36:39], a[80:83], v[28:31]
    ds_read_b128 v[72:75], v19 offset:32768
    ds_read_b128 v[76:79], v19 offset:34816
    ds_read_b64_tr_b16 a[104:105], v20 offset:10240
    ds_read_b64_tr_b16 a[106:107], v20 offset:10368
    ds_read_b64_tr_b16 a[108:109], v20 offset:11264
    ds_read_b64_tr_b16 a[110:111], v20 offset:11392
    s_waitcnt lgkmcnt(15)
    v_mfma_f32_16x16x32_bf16 v[24:27], a[40:43], a[84:87], v[24:27]
    v_mfma_f32_16x16x32_bf16 v[28:31], a[44:47], a[84:87], v[28:31]
    ds_read_b128 v[80:83], v18 offset:40960
    ds_read_b128 v[84:87], v18 offset:43008
    ds_read_b64_tr_b16 a[112:113], v20 offset:12288
    ds_read_b64_tr_b16 a[114:115], v20 offset:12416
    ds_read_b64_tr_b16 a[116:117], v20 offset:13312
    ds_read_b64_tr_b16 a[118:119], v20 offset:13440
    s_waitcnt lgkmcnt(15)
    v_mfma_f32_16x16x32_bf16 v[24:27], a[48:51], a[88:91], v[24:27]
    v_mfma_f32_16x16x32_bf16 v[28:31], a[52:55], a[88:91], v[28:31]
    ds_read_b128 v[88:91], v19 offset:40960
    ds_read_b128 v[92:95], v19 offset:43008
    ds_read_b64_tr_b16 a[120:121], v20 offset:14336
    ds_read_b64_tr_b16 a[122:123], v20 offset:14464
    ds_read_b64_tr_b16 a[124:125], v20 offset:15360
    ds_read_b64_tr_b16 a[126:127], v20 offset:15488
    s_waitcnt lgkmcnt(15)
    v_mfma_f32_16x16x32_bf16 v[24:27], a[56:59], a[92:95], v[24:27]
    v_mfma_f32_16x16x32_bf16 v[28:31], a[60:63], a[92:95], v[28:31]
    s_barrier
    ds_read_b128 v[96:99], v18 offset:49152
    ds_read_b128 v[100:103], v18 offset:51200
    s_waitcnt lgkmcnt(15)
    v_mfma_f32_16x16x32_bf16 v[24:27], v[64:67], a[96:99], v[24:27]
    v_mfma_f32_16x16x32_bf16 v[28:31], v[68:71], a[96:99], v[28:31]
    ds_read_b128 v[104:107], v19 offset:49152
    ds_read_b128 v[108:111], v19 offset:51200
    s_waitcnt lgkmcnt(15)
    v_mfma_f32_16x16x32_bf16 v[24:27], v[72:75], a[100:103], v[24:27]
    v_mfma_f32_16x16x32_bf16 v[28:31], v[76:79], a[100:103], v[28:31]
    ds_read_b128 v[112:115], v18 offset:57344
    ds_read_b128 v[116:119], v18 offset:59392
    s_waitcnt lgkmcnt(15)
    v_mfma_f32_16x16x32_bf16 v[24:27], v[80:83], a[104:107], v[24:27]
    v_mfma_f32_16x16x32_bf16 v[28:31], v[84:87], a[104:107], v[28:31]
    ds_read_b128 v[120:123], v19 offset:57344
    ds_read_b128 v[124:127], v19 offset:59392
    s_waitcnt lgkmcnt(12)
    v_mfma_f32_16x16x32_bf16 v[24:27], v[88:91], a[108:111], v[24:27]
    v_mfma_f32_16x16x32_bf16 v[28:31], v[92:95], a[108:111], v[28:31]
    s_waitcnt lgkmcnt(6)
    v_mfma_f32_16x16x32_bf16 v[24:27], v[96:99], a[112:115], v[24:27]
    v_mfma_f32_16x16x32_bf16 v[28:31], v[100:103], a[112:115], v[28:31]
    s_waitcnt lgkmcnt(4)
    v_mfma_f32_16x16x32_bf16 v[24:27], v[104:107], a[116:119], v[24:27]
    v_mfma_f32_16x16x32_bf16 v[28:31], v[108:111], a[116:119], v[28:31]
    s_waitcnt lgkmcnt(2)
    v_mfma_f32_16x16x32_bf16 v[24:27], v[112:115], a[120:123], v[24:27]
    v_mfma_f32_16x16x32_bf16 v[28:31], v[116:119], a[120:123], v[28:31]
    s_waitcnt lgkmcnt(0)
    v_mfma_f32_16x16x32_bf16 v[24:27], v[120:123], a[124:127], v[24:27]
    v_mfma_f32_16x16x32_bf16 v[28:31], v[124:127], a[124:127], v[28:31]
    s_nop 7
    v_cvt_pk_bf16_f32 v40, v24, v25
    v_cvt_pk_bf16_f32 v41, v26, v27
    v_cvt_pk_bf16_f32 v42, v28, v29
    v_cvt_pk_bf16_f32 v43, v30, v31
    s_nop 0
    v_permlane32_swap_b32 v40, v42
    v_permlane32_swap_b32 v41, v43
    buffer_store_dwordx4 v[40:43], v1, s[24:27], s63 offen offset:1024 sc1
    s_setprio 1
    s_barrier
    s_branch L_jobdone
L_jobG:
    s_waitcnt vmcnt(0)
    s_barrier
    ds_read_b128 a[0:3], v18 offset:0
    ds_read_b128 a[4:7], v18 offset:2048
    ds_read_b128 a[8:11], v19 offset:0
    ds_read_b128 a[12:15], v19 offset:2048
    ds_read_b128 a[16:19], v18 offset:8192
    ds_read_b128 a[20:23], v18 offset:10240
    ds_read_b128 a[24:27], v19 offset:8192
    ds_read_b128 a[28:31], v19 offset:10240
    ds_read_b128 a[64:67], v21 offset:28992
    ds_read_b128 a[80:83], v21 offset:29248
    ds_read_b128 a[68:71], v21 offset:29056
    ds_read_b128 a[84:87], v21 offset:29312
    ds_read_b128 a[72:75], v21 offset:29120
    ds_read_b128 a[88:91], v21 offset:29376
    ds_read_b128 a[76:79], v21 offset:29184
    ds_read_b128 a[92:95], v21 offset:29440
    s_barrier
    ds_read_b128 a[32:35], v18 offset:16384
    ds_read_b128 a[36:39], v18 offset:18432
    s_waitcnt lgkmcnt(9)
    v_mfma_f32_16x16x32_bf16 v[24:27], a[64:67], a[0:3], 0
    v_mfma_f32_16x16x32_bf16 v[28:31], a[64:67], a[4:7], 0
    ds_read_b128 a[40:43], v19 offset:16384
    ds_read_b128 a[44:47], v19 offset:18432
    s_waitcnt lgkmcnt(9)
    v_mfma_f32_16x16x32_bf16 v[24:27], a[68:71], a[8:11], v[24:27]
    v_mfma_f32_16x16x32_bf16 v[28:31], a[68:71], a[12:15], v[28:31]
    ds_read_b128 a[48:51], v18 offset:24576
    ds_read_b128 a[52:55], v18 offset:26624
    s_waitcnt lgkmcnt(9)
    v_mfma_f32_16x16x32_bf16 v[24:27], a[72:75], a[16:19], v[24:27]
    v_mfma_f32_16x16x32_bf16 v[28:31], a[72:75], a[20:23], v[28:31]
    ds_read_b128 a[56:59], v19 offset:24576
    ds_read_b128 a[60:63], v19 offset:26624
    s_waitcnt lgkmcnt(9)
    v_mfma_f32_16x16x32_bf16 v[24:27], a[76:79], a[24:27], v[24:27]
    v_mfma_f32_16x16x32_bf16 v[28:31], a[76:79], a[28:31], v[28:31]
    ds_read_b128 a[96:99], v21 offset:29504
    ds_read_b128 a[100:103], v21 offset:29568
    ds_read_b128 a[104:107], v21 offset:29632
    ds_read_b128 a[108:111], v21 offset:29696
    s_barrier
    ds_read_b128 v[64:67], v18 offset:32768
    ds_read_b128 v[68:71], v18 offset:34816
    s_waitcnt lgkmcnt(12)
    v_mfma_f32_16x16x32_bf16 v[24:27], a[80:83], a[32:35], v[24:27]
    v_mfma_f32_16x16x32_bf16 v[28:31], a[80:83], a[36:39], v[28:31]
    ds_read_b128 v[72:75], v19 offset:32768
    ds_read_b128 v[76:79], v19 offset:34816
    s_waitcnt lgkmcnt(12)
    v_mfma_f32_16x16x32_bf16 v[24:27], a[84:87], a[40:43], v[24:27]
    v_mfma_f32_16x16x32_bf16 v[28:31], a[84:87], a[44:47], v[28:31]
    ds_read_b128 v[80:83], v18 offset:40960
    ds_read_b128 v[84:87], v18 offset:43008
    s_waitcnt lgkmcnt(12)
    v_mfma_f32_16x16x32_bf16 v[24:27], a[88:91], a[48:51], v[24:27]
    v_mfma_f32_16x16x32_bf16 v[28:31], a[88:91], a[52:55], v[28:31]
    ds_read_b128 v[88:91], v19 offset:40960
    ds_read_b128 v[92:95], v19 offset:43008
    s_waitcnt lgkmcnt(12)
    v_mfma_f32_16x16x32_bf16 v[24:27], a[92:95], a[56:59], v[24:27]
    v_mfma_f32_16x16x32_bf16 v[28:31], a[92:95], a[60:63], v[28:31]
    ds_read_b128 a[112:115], v21 offset:29760
    ds_read_b128 a[116:119], v21 offset:29824
    ds_read_b128 a[120:123], v21 offset:29888
    ds_read_b128 a[124:127], v21 offset:29952
    s_barrier
    ds_read_b128 v[96:99], v18 offset:49152
    ds_read_b128 v[100:103], v18 offset:51200
    s_waitcnt lgkmcnt(12)
    v_mfma_f32_16x16x32_bf16 v[24:27], a[96:99], v[64:67], v[24:27]
    v_mfma_f32_16x16x32_bf16 v[28:31], a[96:99], v[68:71], v[28:31]
    ds_read_b128 v[104:107], v19 offset:49152
    ds_read_b128 v[108:111], v19 offset:51200
    s_waitcnt lgkmcnt(12)
    v_mfma_f32_16x16x32_bf16 v[24:27], a[100:103], v[72:75], v[24:27]
    v_mfma_f32_16x16x32_bf16 v[28:31], a[100:103], v[76:79], v[28:31]
    ds_read_b128 v[112:115], v18 offset:57344
    ds_read_b128 v[116:119], v18 offset:59392
    s_waitcnt lgkmcnt(12)
    v_mfma_f32_16x16x32_bf16 v[24:27], a[104:107], v[80:83], v[24:27]
    v_mfma_f32_16x16x32_bf16 v[28:31], a[104:107], v[84:87], v[28:31]
    ds_read_b128 v[120:123], v19 offset:57344
    ds_read_b128 v[124:127], v19 offset:59392
    s_waitcnt lgkmcnt(12)
    v_mfma_f32_16x16x32_bf16 v[24:27], a[108:111], v[88:91], v[24:27]
    v_mfma_f32_16x16x32_bf16 v[28:31], a[108:111], v[92:95], v[28:31]
    s_barrier
    s_waitcnt lgkmcnt(6)
    v_mfma_f32_16x16x32_bf16 v[24:27], a[112:115], v[96:99], v[24:27]
    v_mfma_f32_16x16x32_bf16 v[28:31], a[112:115], v[100:103], v[28:31]
    s_waitcnt lgkmcnt(4)
    v_mfma_f32_16x16x32_bf16 v[24:27], a[116:119], v[104:107], v[24:27]
    v_mfma_f32_16x16x32_bf16 v[28:31], a[116:119], v[108:111], v[28:31]
    s_waitcnt lgkmcnt(2)
    v_mfma_f32_16x16x32_bf16 v[24:27], a[120:123], v[112:115], v[24:27]
    v_mfma_f32_16x16x32_bf16 v[28:31], a[120:123], v[116:119], v[28:31]
    s_waitcnt lgkmcnt(0)
    v_mfma_f32_16x16x32_bf16 v[24:27], a[124:127], v[120:123], v[24:27]
    v_mfma_f32_16x16x32_bf16 v[28:31], a[124:127], v[124:127], v[28:31]
    s_nop 7
    s_mov_b32 s64, 0xffff0000
    s_mov_b32 s65, 0xffff0000
    v_cndmask_b32 v40, v24, v28, s[64:65]
    v_mul_f32 v40, 0xbfb8aa3b, v40
    v_exp_f32 v40, v40
    s_nop 0
    v_add_f32 v40, 1.0, v40
    v_rcp_f32 v40, v40
    s_branch L_jobdone
.p2align 12
L_jobdone:
    v_add_u32 v16, s59, v1
    ds_read_b128 v[8:11], v16 offset:26944
    s_barrier
    s_barrier
    s_barrier
    s_mov_b64 s[64:65], s[92:93]
    s_mov_b64 exec, 0
    s_call_b64 s[92:93], L_pg4
    s_mov_b64 exec, -1
    s_mov_b64 s[92:93], s[64:65]
    s_waitcnt lgkmcnt(0)
    v_lshlrev_b32 v12, 16, v8
    v_and_b32 v13, 0xffff0000, v8
    v_mul_f32 v12, 0x3fb8aa3b, v12
    v_mul_f32 v13, 0x3fb8aa3b, v13
    v_cvt_pk_bf16_f32 v8, v12, v13
    v_lshlrev_b32 v12, 16, v9
    v_and_b32 v13, 0xffff0000, v9
    v_mul_f32 v12, 0x3fb8aa3b, v12
    v_mul_f32 v13, 0x3fb8aa3b, v13
    v_cvt_pk_bf16_f32 v9, v12, v13
    v_lshlrev_b32 v12, 16, v10
    v_and_b32 v13, 0xffff0000, v10
    v_mul_f32 v12, 0x3fb8aa3b, v12
    v_mul_f32 v13, 0x3fb8aa3b, v13
    v_cvt_pk_bf16_f32 v10, v12, v13
    v_lshlrev_b32 v12, 16, v11
    v_and_b32 v13, 0xffff0000, v11
    v_mul_f32 v12, 0x3fb8aa3b, v12
    v_mul_f32 v13, 0x3fb8aa3b, v13
    v_cvt_pk_bf16_f32 v11, v12, v13

L_B9:
    s_barrier
    v_mov_b32 v14, 0
    s_mov_b64 exec, 0x30003
    buffer_load_dword v14, v0, s[24:27], 0 offen offset:1020 sc1
    s_mov_b64 exec, -1
    global_load_dwordx4 v[64:67], v1, s[28:29] sc1
    global_load_dwordx4 a[0:3], v4, s[28:29] offset:1024 sc1
    global_load_dwordx4 a[4:7], v5, s[28:29] offset:1536 sc1
    global_load_dwordx4 v[68:71], v1, s[30:31] sc1
    global_load_dwordx4 a[8:11], v4, s[30:31] offset:1024 sc1
    global_load_dwordx4 a[12:15], v5, s[30:31] offset:1536 sc1
    v_mov_b32 v6, 0xdddddddd
    s_mov_b32 s3, 4
    s_cmp_lt_u32 s52, 2
    s_cbranch_scc1 L_B10
    s_waitcnt vmcnt(7)
L_B10:
    s_waitcnt lgkmcnt(0)
    s_barrier
    s_mov_b64 exec, 0xc000c
    buffer_load_dword v2, v0, s[24:27], 0 offen offset:1020 sc1
    s_mov_b64 exec, -1
    global_load_dwordx4 v[72:75], v1, s[32:33] sc1
    global_load_dwordx4 a[16:19], v4, s[32:33] offset:1024 sc1
    global_load_dwordx4 a[20:23], v5, s[32:33] offset:1536 sc1
    global_load_dwordx4 v[76:79], v1, s[34:35] sc1
    global_load_dwordx4 a[24:27], v4, s[34:35] offset:1024 sc1
    global_load_dwordx4 a[28:31], v5, s[34:35] offset:1536 sc1
    s_cmp_lt_u32 s52, 2
    s_cbranch_scc0 L_B11
    ds_write_b128 v16, v[8:11] offset:26944
    s_cmp_eq_u32 s56, 3
    s_cbranch_scc0 L_nogs
    ds_write_b32 v23, v40 offset:26688
L_nogs:
    s_waitcnt lgkmcnt(0)
L_B11:
    s_barrier
    ds_read_b128 v[56:59], v3
L_kvok:
    v_mfma_f32_32x32x8_bf16 v[40:55], v[60:61], v[60:61], 0
    s_waitcnt vmcnt(12) lgkmcnt(0)
    v_cmp_eq_u32 vcc, -1, v14
    s_cbranch_vccnz L_kvretry
L_kvgo:
    v_mfma_f32_32x32x16_bf16 v[8:23], v[64:67], v[56:59], 0
    s_mov_b32 m0, s73
    s_nop 10
    v_exp_f32 v8, v8
    v_exp_f32 v9, v9
    s_waitcnt vmcnt(9)
    v_exp_f32 v10, v10
    v_exp_f32 v11, v11
    v_exp_f32 v12, v12
    v_mfma_f32_32x32x16_bf16 v[24:39], v[68:71], v[56:59], 0
    v_exp_f32 v13, v13
    v_exp_f32 v14, v14
    v_exp_f32 v15, v15
    v_exp_f32 v16, v16
    v_exp_f32 v17, v17
    v_exp_f32 v18, v18
    v_exp_f32 v19, v19
    v_smfmac_f32_32x32x32_bf16 v[40:55], a[0:3], v[8:15], v6
    global_load_dwordx4 v[80:83], v1, s[36:37] sc1
    global_load_dwordx4 a[32:35], v4, s[36:37] offset:1024 sc1
    global_load_dwordx4 a[36:39], v5, s[36:37] offset:1536 sc1
    v_exp_f32 v20, v20
    v_exp_f32 v21, v21
    v_exp_f32 v22, v22
    v_exp_f32 v23, v23
    v_exp_f32 v24, v24
    v_exp_f32 v25, v25
    v_smfmac_f32_32x32x32_bf16 v[40:55], a[4:7], v[16:23], v6
L_p1w:
    s_waitcnt vmcnt(8)
    v_cmp_eq_u32 vcc, -1, v2
    s_cbranch_vccnz L_p1r
L_p1g:
    v_exp_f32 v26, v26
    v_exp_f32 v27, v27
    v_exp_f32 v28, v28
    v_mfma_f32_32x32x16_bf16 v[8:23], v[72:75], v[56:59], 0
    v_exp_f32 v29, v29
    v_exp_f32 v30, v30
    v_exp_f32 v31, v31
    v_exp_f32 v32, v32
    v_exp_f32 v33, v33
    v_exp_f32 v34, v34
    v_exp_f32 v35, v35
    v_smfmac_f32_32x32x32_bf16 v[40:55], a[8:11], v[24:31], v6
    global_load_dwordx4 v[84:87], v1, s[38:39] sc1
    global_load_dwordx4 a[40:43], v4, s[38:39] offset:1024 sc1
    global_load_dwordx4 a[44:47], v5, s[38:39] offset:1536 sc1
    global_load_dwordx4 v[88:91], v1, s[40:41] sc1
    global_load_dwordx4 a[48:51], v4, s[40:41] offset:1024 sc1
    global_load_dwordx4 a[52:55], v5, s[40:41] offset:1536 sc1
    v_exp_f32 v36, v36
    v_exp_f32 v37, v37
    v_exp_f32 v38, v38
    v_exp_f32 v39, v39
    v_exp_f32 v8, v8
    v_exp_f32 v9, v9
    v_smfmac_f32_32x32x32_bf16 v[40:55], a[12:15], v[32:39], v6
    s_waitcnt vmcnt(11)
    v_exp_f32 v10, v10
    v_exp_f32 v11, v11
    v_exp_f32 v12, v12
    v_mfma_f32_32x32x16_bf16 v[24:39], v[76:79], v[56:59], 0
    v_exp_f32 v13, v13
    v_exp_f32 v14, v14
    v_exp_f32 v15, v15
    v_exp_f32 v16, v16
    v_exp_f32 v17, v17
    v_exp_f32 v18, v18
    v_exp_f32 v19, v19
    v_smfmac_f32_32x32x32_bf16 v[40:55], a[16:19], v[8:15], v6
    global_load_dwordx4 v[92:95], v1, s[42:43] sc1
    global_load_dwordx4 a[56:59], v4, s[42:43] offset:1024 sc1
    global_load_dwordx4 a[60:63], v5, s[42:43] offset:1536 sc1
    v_exp_f32 v20, v20
    v_exp_f32 v21, v21
    v_exp_f32 v22, v22
    v_exp_f32 v23, v23
    v_exp_f32 v24, v24
    v_exp_f32 v25, v25
    v_smfmac_f32_32x32x32_bf16 v[40:55], a[20:23], v[16:23], v6
    s_waitcnt vmcnt(11)
    v_exp_f32 v26, v26
    v_exp_f32 v27, v27
    v_exp_f32 v28, v28
    v_mfma_f32_32x32x16_bf16 v[8:23], v[80:83], v[56:59], 0
    v_exp_f32 v29, v29
    v_exp_f32 v30, v30
    v_exp_f32 v31, v31
    v_exp_f32 v32, v32
    v_exp_f32 v33, v33
    v_exp_f32 v34, v34
    v_exp_f32 v35, v35
    v_cmp_u_f32 vcc, v40, v44
    v_smfmac_f32_32x32x32_bf16 v[40:55], a[24:27], v[24:31], v6
    s_cbranch_vccnz L_rs3
L_ct3:
    global_load_dwordx4 v[96:99], v1, s[44:45] sc1
    global_load_dwordx4 a[64:67], v4, s[44:45] offset:1024 sc1
    global_load_dwordx4 a[68:71], v5, s[44:45] offset:1536 sc1
    v_exp_f32 v36, v36
    v_exp_f32 v37, v37
    v_exp_f32 v38, v38
    v_exp_f32 v39, v39
    v_exp_f32 v8, v8
    v_exp_f32 v9, v9
    v_smfmac_f32_32x32x32_bf16 v[40:55], a[28:31], v[32:39], v6
    s_waitcnt vmcnt(11)
    v_exp_f32 v10, v10
    v_exp_f32 v11, v11
    v_exp_f32 v12, v12
    v_mfma_f32_32x32x16_bf16 v[24:39], v[84:87], v[56:59], 0
    v_exp_f32 v13, v13
    v_exp_f32 v14, v14
    v_exp_f32 v15, v15
    v_exp_f32 v16, v16
    v_exp_f32 v17, v17
    v_exp_f32 v18, v18
    v_exp_f32 v19, v19
    v_smfmac_f32_32x32x32_bf16 v[40:55], a[32:35], v[8:15], v6
    global_load_dwordx4 v[100:103], v1, s[46:47] sc1
    global_load_dwordx4 a[72:75], v4, s[46:47] offset:1024 sc1
    global_load_dwordx4 a[76:79], v5, s[46:47] offset:1536 sc1
    v_exp_f32 v20, v20
    v_exp_f32 v21, v21
    v_exp_f32 v22, v22
    v_exp_f32 v23, v23
    v_exp_f32 v24, v24
    v_exp_f32 v25, v25
    v_smfmac_f32_32x32x32_bf16 v[40:55], a[36:39], v[16:23], v6
    s_waitcnt vmcnt(11)
    v_exp_f32 v26, v26
    v_exp_f32 v27, v27
    v_exp_f32 v28, v28
    v_mfma_f32_32x32x16_bf16 v[8:23], v[88:91], v[56:59], 0
    v_exp_f32 v29, v29
    v_exp_f32 v30, v30
    v_exp_f32 v31, v31
    v_exp_f32 v32, v32
    v_exp_f32 v33, v33
    v_exp_f32 v34, v34
    v_exp_f32 v35, v35
    v_smfmac_f32_32x32x32_bf16 v[40:55], a[40:43], v[24:31], v6
    global_load_dwordx4 v[104:107], v1, s[78:79] sc1
    global_load_dwordx4 a[80:83], v4, s[78:79] offset:1024 sc1
    global_load_dwordx4 a[84:87], v5, s[78:79] offset:1536 sc1
    v_exp_f32 v36, v36
    v_exp_f32 v37, v37
    v_exp_f32 v38, v38
    v_exp_f32 v39, v39
    v_exp_f32 v8, v8
    v_exp_f32 v9, v9
    v_smfmac_f32_32x32x32_bf16 v[40:55], a[44:47], v[32:39], v6
    s_waitcnt vmcnt(8)
    v_exp_f32 v10, v10
    v_exp_f32 v11, v11
    v_exp_f32 v12, v12
    v_mfma_f32_32x32x16_bf16 v[24:39], v[92:95], v[56:59], 0
    v_exp_f32 v13, v13
    v_exp_f32 v14, v14
    v_exp_f32 v15, v15
    v_exp_f32 v16, v16
    v_exp_f32 v17, v17
    v_exp_f32 v18, v18
    v_exp_f32 v19, v19
    v_cmp_u_f32 vcc, v40, v44
    v_smfmac_f32_32x32x32_bf16 v[40:55], a[48:51], v[8:15], v6
    s_cbranch_vccnz L_rs6
L_ct6:
    global_load_dwordx4 v[108:111], v1, s[80:81] sc1
    global_load_dwordx4 a[88:91], v4, s[80:81] offset:1024 sc1
    global_load_dwordx4 a[92:95], v5, s[80:81] offset:1536 sc1
    v_exp_f32 v20, v20
    v_exp_f32 v21, v21
    v_exp_f32 v22, v22
    v_exp_f32 v23, v23
    v_exp_f32 v24, v24
    v_exp_f32 v25, v25
    v_smfmac_f32_32x32x32_bf16 v[40:55], a[52:55], v[16:23], v6
    v_exp_f32 v26, v26
    v_exp_f32 v27, v27
    v_exp_f32 v28, v28
    v_mfma_f32_32x32x16_bf16 v[8:23], v[96:99], v[56:59], 0
    v_exp_f32 v29, v29
    v_exp_f32 v30, v30
    v_exp_f32 v31, v31
    v_exp_f32 v32, v32
    v_exp_f32 v33, v33
    v_exp_f32 v34, v34
    v_exp_f32 v35, v35
    v_smfmac_f32_32x32x32_bf16 v[40:55], a[56:59], v[24:31], v6
    global_load_dwordx4 v[112:115], v1, s[82:83] sc1
    global_load_dwordx4 a[96:99], v4, s[82:83] offset:1024 sc1
    global_load_dwordx4 a[100:103], v5, s[82:83] offset:1536 sc1
    v_exp_f32 v36, v36
    v_exp_f32 v37, v37
    v_exp_f32 v38, v38
    v_exp_f32 v39, v39
    v_exp_f32 v8, v8
    v_exp_f32 v9, v9
    v_smfmac_f32_32x32x32_bf16 v[40:55], a[60:63], v[32:39], v6
    s_waitcnt vmcnt(8)
    v_exp_f32 v10, v10
    v_exp_f32 v11, v11
    v_exp_f32 v12, v12
    v_mfma_f32_32x32x16_bf16 v[24:39], v[100:103], v[56:59], 0
    v_exp_f32 v13, v13
    v_exp_f32 v14, v14
    v_exp_f32 v15, v15
    v_exp_f32 v16, v16
    v_exp_f32 v17, v17
    v_exp_f32 v18, v18
    v_exp_f32 v19, v19
    v_smfmac_f32_32x32x32_bf16 v[40:55], a[64:67], v[8:15], v6
    global_load_dwordx4 v[116:119], v1, s[84:85] sc1
    global_load_dwordx4 a[104:107], v4, s[84:85] offset:1024 sc1
    global_load_dwordx4 a[108:111], v5, s[84:85] offset:1536 sc1
    v_exp_f32 v20, v20
    v_exp_f32 v21, v21
    v_exp_f32 v22, v22
    v_exp_f32 v23, v23
    v_exp_f32 v24, v24
    v_exp_f32 v25, v25
    v_smfmac_f32_32x32x32_bf16 v[40:55], a[68:71], v[16:23], v6
    v_exp_f32 v26, v26
    v_exp_f32 v27, v27
    v_exp_f32 v28, v28
    v_mfma_f32_32x32x16_bf16 v[8:23], v[104:107], v[56:59], 0
    v_exp_f32 v29, v29
    v_exp_f32 v30, v30
    v_exp_f32 v31, v31
    v_exp_f32 v32, v32
    v_exp_f32 v33, v33
    v_exp_f32 v34, v34
    v_exp_f32 v35, v35
    v_smfmac_f32_32x32x32_bf16 v[40:55], a[72:75], v[24:31], v6
    global_load_dwordx4 v[120:123], v1, s[86:87] sc1
    global_load_dwordx4 a[112:115], v4, s[86:87] offset:1024 sc1
    global_load_dwordx4 a[116:119], v5, s[86:87] offset:1536 sc1
    v_exp_f32 v36, v36
    v_exp_f32 v37, v37
    v_exp_f32 v38, v38
    v_exp_f32 v39, v39
    v_exp_f32 v8, v8
    v_exp_f32 v9, v9
    v_smfmac_f32_32x32x32_bf16 v[40:55], a[76:79], v[32:39], v6
    s_waitcnt vmcnt(8)
    v_exp_f32 v10, v10
    v_exp_f32 v11, v11
    v_exp_f32 v12, v12
    v_mfma_f32_32x32x16_bf16 v[24:39], v[108:111], v[56:59], 0
    v_exp_f32 v13, v13
    v_exp_f32 v14, v14
    v_exp_f32 v15, v15
    v_exp_f32 v16, v16
    v_exp_f32 v17, v17
    v_exp_f32 v18, v18
    v_exp_f32 v19, v19
    v_cmp_u_f32 vcc, v40, v44
    v_smfmac_f32_32x32x32_bf16 v[40:55], a[80:83], v[8:15], v6
    s_cbranch_vccnz L_rs10
L_ct10:
    global_load_dwordx4 v[124:127], v1, s[88:89] sc1
    global_load_dwordx4 a[120:123], v4, s[88:89] offset:1024 sc1
    global_load_dwordx4 a[124:127], v5, s[88:89] offset:1536 sc1
    ds_inc_u32 v60, v6 offset:26628
    v_exp_f32 v20, v20
    v_exp_f32 v21, v21
    v_exp_f32 v22, v22
    v_exp_f32 v23, v23
    v_exp_f32 v24, v24
    v_exp_f32 v25, v25
    v_smfmac_f32_32x32x32_bf16 v[40:55], a[84:87], v[16:23], v6
    v_exp_f32 v26, v26
    v_exp_f32 v27, v27
    v_exp_f32 v28, v28
    v_mfma_f32_32x32x16_bf16 v[8:23], v[112:115], v[56:59], 0
    v_exp_f32 v29, v29
    v_exp_f32 v30, v30
    v_exp_f32 v31, v31
    v_exp_f32 v32, v32
    v_exp_f32 v33, v33
    v_exp_f32 v34, v34
    v_exp_f32 v35, v35
    v_smfmac_f32_32x32x32_bf16 v[40:55], a[88:91], v[24:31], v6
    v_exp_f32 v36, v36
    v_exp_f32 v37, v37
    v_exp_f32 v38, v38
    v_exp_f32 v39, v39
    v_exp_f32 v8, v8
    v_exp_f32 v9, v9
    v_smfmac_f32_32x32x32_bf16 v[40:55], a[92:95], v[32:39], v6
    s_waitcnt vmcnt(5)
    v_exp_f32 v10, v10
    v_exp_f32 v11, v11
    v_exp_f32 v12, v12
    v_mfma_f32_32x32x16_bf16 v[24:39], v[116:119], v[56:59], 0
    v_exp_f32 v13, v13
    v_exp_f32 v14, v14
    v_exp_f32 v15, v15
    v_exp_f32 v16, v16
    v_exp_f32 v17, v17
    v_exp_f32 v18, v18
    v_exp_f32 v19, v19
    v_smfmac_f32_32x32x32_bf16 v[40:55], a[96:99], v[8:15], v6
    v_exp_f32 v20, v20
    v_exp_f32 v21, v21
    v_exp_f32 v22, v22
    v_exp_f32 v23, v23
    v_exp_f32 v24, v24
    v_exp_f32 v25, v25
    v_smfmac_f32_32x32x32_bf16 v[40:55], a[100:103], v[16:23], v6
    v_exp_f32 v26, v26
    v_exp_f32 v27, v27
    v_exp_f32 v28, v28
    v_mfma_f32_32x32x16_bf16 v[8:23], v[120:123], v[56:59], 0
    v_exp_f32 v29, v29
    v_exp_f32 v30, v30
    v_exp_f32 v31, v31
    v_exp_f32 v32, v32
    v_exp_f32 v33, v33
    v_exp_f32 v34, v34
    v_exp_f32 v35, v35
    v_smfmac_f32_32x32x32_bf16 v[40:55], a[104:107], v[24:31], v6
    v_exp_f32 v36, v36
    v_exp_f32 v37, v37
    v_exp_f32 v38, v38
    v_exp_f32 v39, v39
    v_exp_f32 v8, v8
    v_exp_f32 v9, v9
    v_smfmac_f32_32x32x32_bf16 v[40:55], a[108:111], v[32:39], v6
    s_waitcnt vmcnt(2)
    v_exp_f32 v10, v10
    v_exp_f32 v11, v11
    v_exp_f32 v12, v12
    v_mfma_f32_32x32x16_bf16 v[24:39], v[124:127], v[56:59], 0
    ds_read_b128 v[56:59], v3 offset:1024
    v_exp_f32 v13, v13
    v_exp_f32 v14, v14
    v_exp_f32 v15, v15
    v_exp_f32 v16, v16
    v_exp_f32 v17, v17
    v_exp_f32 v18, v18
    v_exp_f32 v19, v19
    v_smfmac_f32_32x32x32_bf16 v[40:55], a[112:115], v[8:15], v6
    v_exp_f32 v20, v20
    v_exp_f32 v21, v21
    v_exp_f32 v22, v22
    v_exp_f32 v23, v23
    v_exp_f32 v24, v24
    v_exp_f32 v25, v25
    v_smfmac_f32_32x32x32_bf16 v[40:55], a[116:119], v[16:23], v6
    s_waitcnt vmcnt(0) lgkmcnt(0)
    v_exp_f32 v26, v26
    v_exp_f32 v27, v27
    v_exp_f32 v28, v28
    v_mfma_f32_32x32x16_bf16 v[8:23], v[64:67], v[56:59], 0
    v_exp_f32 v29, v29
    v_exp_f32 v30, v30
    v_exp_f32 v31, v31
    v_exp_f32 v32, v32
    v_exp_f32 v33, v33
    v_exp_f32 v34, v34
    v_exp_f32 v35, v35
    v_smfmac_f32_32x32x32_bf16 v[40:55], a[120:123], v[24:31], v6
    v_exp_f32 v36, v36
    v_exp_f32 v37, v37
    v_exp_f32 v38, v38
    v_exp_f32 v39, v39
    v_exp_f32 v8, v8
    v_exp_f32 v9, v9
    v_smfmac_f32_32x32x32_bf16 v[40:55], a[124:127], v[32:39], v6
    v_exp_f32 v10, v10
    v_exp_f32 v11, v11
    v_exp_f32 v12, v12
    v_exp_f32 v13, v13
    v_exp_f32 v14, v14
    v_exp_f32 v15, v15
    v_cmp_u_f32 vcc, v40, v44
    v_mfma_f32_32x32x16_bf16 v[24:39], v[68:71], v[56:59], 0
    s_cbranch_vccnz L_rs16
L_ct16:
    ds_write_addtid_b32 v40 offset:0
    ds_write_addtid_b32 v41 offset:256
    ds_write_addtid_b32 v42 offset:512
    ds_write_addtid_b32 v43 offset:768
    ds_write_addtid_b32 v44 offset:1024
    ds_write_addtid_b32 v45 offset:1280
    ds_write_addtid_b32 v46 offset:1536
    ds_write_addtid_b32 v47 offset:1792
    ds_write_addtid_b32 v48 offset:2048
    v_mfma_f32_32x32x8_bf16 v[40:55], v[60:61], v[60:61], 0
    v_exp_f32 v16, v16
    v_exp_f32 v17, v17
    v_exp_f32 v18, v18
    v_exp_f32 v19, v19
    v_exp_f32 v20, v20
    v_smfmac_f32_32x32x32_bf16 v[40:55], a[0:3], v[8:15], v6
    v_exp_f32 v21, v21
    v_exp_f32 v22, v22
    v_exp_f32 v23, v23
    v_exp_f32 v24, v24
    v_exp_f32 v25, v25
    v_smfmac_f32_32x32x32_bf16 v[40:55], a[4:7], v[16:23], v6
    v_exp_f32 v26, v26
    v_exp_f32 v27, v27
    v_exp_f32 v28, v28
    v_mfma_f32_32x32x16_bf16 v[8:23], v[72:75], v[56:59], 0
    v_exp_f32 v29, v29
    v_exp_f32 v30, v30
    v_exp_f32 v31, v31
    v_exp_f32 v32, v32
    v_exp_f32 v33, v33
    v_exp_f32 v34, v34
    v_exp_f32 v35, v35
    v_smfmac_f32_32x32x32_bf16 v[40:55], a[8:11], v[24:31], v6
    v_exp_f32 v36, v36
    v_exp_f32 v37, v37
    v_exp_f32 v38, v38
    v_exp_f32 v39, v39
    v_exp_f32 v8, v8
    v_exp_f32 v9, v9
    v_smfmac_f32_32x32x32_bf16 v[40:55], a[12:15], v[32:39], v6
    v_exp_f32 v10, v10
    v_exp_f32 v11, v11
    v_exp_f32 v12, v12
    v_mfma_f32_32x32x16_bf16 v[24:39], v[76:79], v[56:59], 0
    v_exp_f32 v13, v13
    v_exp_f32 v14, v14
    v_exp_f32 v15, v15
    v_exp_f32 v16, v16
    v_exp_f32 v17, v17
    v_exp_f32 v18, v18
    v_exp_f32 v19, v19
    v_smfmac_f32_32x32x32_bf16 v[40:55], a[16:19], v[8:15], v6
    v_exp_f32 v20, v20
    v_exp_f32 v21, v21
    v_exp_f32 v22, v22
    v_exp_f32 v23, v23
    v_exp_f32 v24, v24
    v_exp_f32 v25, v25
    v_smfmac_f32_32x32x32_bf16 v[40:55], a[20:23], v[16:23], v6
    v_exp_f32 v26, v26
    v_exp_f32 v27, v27
    v_exp_f32 v28, v28
    v_mfma_f32_32x32x16_bf16 v[8:23], v[80:83], v[56:59], 0
    v_exp_f32 v29, v29
    v_exp_f32 v30, v30
    v_exp_f32 v31, v31
    v_exp_f32 v32, v32
    v_exp_f32 v33, v33
    v_exp_f32 v34, v34
    v_exp_f32 v35, v35
    v_smfmac_f32_32x32x32_bf16 v[40:55], a[24:27], v[24:31], v6
    v_exp_f32 v36, v36
    v_exp_f32 v37, v37
    v_exp_f32 v38, v38
    v_exp_f32 v39, v39
    v_exp_f32 v8, v8
    v_exp_f32 v9, v9
    v_smfmac_f32_32x32x32_bf16 v[40:55], a[28:31], v[32:39], v6
    v_exp_f32 v10, v10
    v_exp_f32 v11, v11
    v_exp_f32 v12, v12
    v_mfma_f32_32x32x16_bf16 v[24:39], v[84:87], v[56:59], 0
    v_exp_f32 v13, v13
    v_exp_f32 v14, v14
    v_exp_f32 v15, v15
    v_exp_f32 v16, v16
    v_exp_f32 v17, v17
    v_exp_f32 v18, v18
    v_exp_f32 v19, v19
    v_smfmac_f32_32x32x32_bf16 v[40:55], a[32:35], v[8:15], v6
    v_exp_f32 v20, v20
    v_exp_f32 v21, v21
    v_exp_f32 v22, v22
    v_exp_f32 v23, v23
    v_exp_f32 v24, v24
    v_exp_f32 v25, v25
    v_smfmac_f32_32x32x32_bf16 v[40:55], a[36:39], v[16:23], v6
    v_exp_f32 v26, v26
    v_exp_f32 v27, v27
    v_exp_f32 v28, v28
    v_mfma_f32_32x32x16_bf16 v[8:23], v[88:91], v[56:59], 0
    v_exp_f32 v29, v29
    v_exp_f32 v30, v30
    v_exp_f32 v31, v31
    v_exp_f32 v32, v32
    v_exp_f32 v33, v33
    v_exp_f32 v34, v34
    v_exp_f32 v35, v35
    v_smfmac_f32_32x32x32_bf16 v[40:55], a[40:43], v[24:31], v6
    v_exp_f32 v36, v36
    v_exp_f32 v37, v37
    v_exp_f32 v38, v38
    v_exp_f32 v39, v39
    v_exp_f32 v8, v8
    v_exp_f32 v9, v9
    v_smfmac_f32_32x32x32_bf16 v[40:55], a[44:47], v[32:39], v6
    v_exp_f32 v10, v10
    v_exp_f32 v11, v11
    v_exp_f32 v12, v12
    v_mfma_f32_32x32x16_bf16 v[24:39], v[92:95], v[56:59], 0
    v_exp_f32 v13, v13
    v_exp_f32 v14, v14
    v_exp_f32 v15, v15
    v_exp_f32 v16, v16
    v_exp_f32 v17, v17
    v_exp_f32 v18, v18
    v_exp_f32 v19, v19
    v_smfmac_f32_32x32x32_bf16 v[40:55], a[48:51], v[8:15], v6
    v_exp_f32 v20, v20
    v_exp_f32 v21, v21
    v_exp_f32 v22, v22
    v_exp_f32 v23, v23
    v_exp_f32 v24, v24
    v_exp_f32 v25, v25
    v_smfmac_f32_32x32x32_bf16 v[40:55], a[52:55], v[16:23], v6
    v_exp_f32 v26, v26
    v_exp_f32 v27, v27
    v_exp_f32 v28, v28
    v_mfma_f32_32x32x16_bf16 v[8:23], v[96:99], v[56:59], 0
    v_exp_f32 v29, v29
    v_exp_f32 v30, v30
    v_exp_f32 v31, v31
    v_exp_f32 v32, v32
    v_exp_f32 v33, v33
    v_exp_f32 v34, v34
    v_exp_f32 v35, v35
    v_smfmac_f32_32x32x32_bf16 v[40:55], a[56:59], v[24:31], v6
    v_exp_f32 v36, v36
    v_exp_f32 v37, v37
    v_exp_f32 v38, v38
    v_exp_f32 v39, v39
    v_exp_f32 v8, v8
    v_exp_f32 v9, v9
    v_smfmac_f32_32x32x32_bf16 v[40:55], a[60:63], v[32:39], v6
    v_exp_f32 v10, v10
    v_exp_f32 v11, v11
    v_exp_f32 v12, v12
    v_mfma_f32_32x32x16_bf16 v[24:39], v[100:103], v[56:59], 0
    v_exp_f32 v13, v13
    v_exp_f32 v14, v14
    v_exp_f32 v15, v15
    v_exp_f32 v16, v16
    v_exp_f32 v17, v17
    v_exp_f32 v18, v18
    v_exp_f32 v19, v19
    v_smfmac_f32_32x32x32_bf16 v[40:55], a[64:67], v[8:15], v6
    v_exp_f32 v20, v20
    v_exp_f32 v21, v21
    v_exp_f32 v22, v22
    v_exp_f32 v23, v23
    v_exp_f32 v24, v24
    v_exp_f32 v25, v25
    v_smfmac_f32_32x32x32_bf16 v[40:55], a[68:71], v[16:23], v6
    v_exp_f32 v26, v26
    v_exp_f32 v27, v27
    v_exp_f32 v28, v28
    v_mfma_f32_32x32x16_bf16 v[8:23], v[104:107], v[56:59], 0
    v_exp_f32 v29, v29
    v_exp_f32 v30, v30
    v_exp_f32 v31, v31
    v_exp_f32 v32, v32
    v_exp_f32 v33, v33
    v_exp_f32 v34, v34
    v_exp_f32 v35, v35
    v_smfmac_f32_32x32x32_bf16 v[40:55], a[72:75], v[24:31], v6
    v_exp_f32 v36, v36
    v_exp_f32 v37, v37
    v_exp_f32 v38, v38
    v_exp_f32 v39, v39
    v_exp_f32 v8, v8
    v_exp_f32 v9, v9
    v_smfmac_f32_32x32x32_bf16 v[40:55], a[76:79], v[32:39], v6
    v_exp_f32 v10, v10
    v_exp_f32 v11, v11
    v_exp_f32 v12, v12
    v_mfma_f32_32x32x16_bf16 v[24:39], v[108:111], v[56:59], 0
    v_exp_f32 v13, v13
    v_exp_f32 v14, v14
    v_exp_f32 v15, v15
    v_exp_f32 v16, v16
    v_exp_f32 v17, v17
    v_exp_f32 v18, v18
    v_exp_f32 v19, v19
    v_smfmac_f32_32x32x32_bf16 v[40:55], a[80:83], v[8:15], v6
    v_exp_f32 v20, v20
    v_exp_f32 v21, v21
    v_exp_f32 v22, v22
    v_exp_f32 v23, v23
    v_exp_f32 v24, v24
    v_exp_f32 v25, v25
    v_smfmac_f32_32x32x32_bf16 v[40:55], a[84:87], v[16:23], v6
    v_exp_f32 v26, v26
    v_exp_f32 v27, v27
    v_exp_f32 v28, v28
    v_mfma_f32_32x32x16_bf16 v[8:23], v[112:115], v[56:59], 0
    v_exp_f32 v29, v29
    v_exp_f32 v30, v30
    v_exp_f32 v31, v31
    v_exp_f32 v32, v32
    v_exp_f32 v33, v33
    v_exp_f32 v34, v34
    v_exp_f32 v35, v35
    v_smfmac_f32_32x32x32_bf16 v[40:55], a[88:91], v[24:31], v6
    v_exp_f32 v36, v36
    v_exp_f32 v37, v37
    v_exp_f32 v38, v38
    v_exp_f32 v39, v39
    v_exp_f32 v8, v8
    v_exp_f32 v9, v9
    v_smfmac_f32_32x32x32_bf16 v[40:55], a[92:95], v[32:39], v6
    v_exp_f32 v10, v10
    v_exp_f32 v11, v11
    v_exp_f32 v12, v12
    v_mfma_f32_32x32x16_bf16 v[24:39], v[116:119], v[56:59], 0
    v_exp_f32 v13, v13
    v_exp_f32 v14, v14
    v_exp_f32 v15, v15
    v_exp_f32 v16, v16
    v_exp_f32 v17, v17
    v_exp_f32 v18, v18
    v_exp_f32 v19, v19
    v_smfmac_f32_32x32x32_bf16 v[40:55], a[96:99], v[8:15], v6
    v_exp_f32 v20, v20
    v_exp_f32 v21, v21
    v_exp_f32 v22, v22
    v_exp_f32 v23, v23
    v_exp_f32 v24, v24
    v_exp_f32 v25, v25
    v_smfmac_f32_32x32x32_bf16 v[40:55], a[100:103], v[16:23], v6
    v_exp_f32 v26, v26
    v_exp_f32 v27, v27
    v_exp_f32 v28, v28
    v_mfma_f32_32x32x16_bf16 v[8:23], v[120:123], v[56:59], 0
    v_exp_f32 v29, v29
    v_exp_f32 v30, v30
    v_exp_f32 v31, v31
    v_exp_f32 v32, v32
    v_exp_f32 v33, v33
    v_exp_f32 v34, v34
    v_exp_f32 v35, v35
    v_smfmac_f32_32x32x32_bf16 v[40:55], a[104:107], v[24:31], v6
    v_exp_f32 v36, v36
    v_exp_f32 v37, v37
    v_exp_f32 v38, v38
    v_exp_f32 v39, v39
    v_exp_f32 v8, v8
    v_exp_f32 v9, v9
    v_smfmac_f32_32x32x32_bf16 v[40:55], a[108:111], v[32:39], v6
    v_exp_f32 v10, v10
    v_exp_f32 v11, v11
    v_exp_f32 v12, v12
    v_mfma_f32_32x32x16_bf16 v[24:39], v[124:127], v[56:59], 0
    ds_read_b128 v[56:59], v3 offset:2048
    v_exp_f32 v13, v13
    v_exp_f32 v14, v14
    v_exp_f32 v15, v15
    v_exp_f32 v16, v16
    v_exp_f32 v17, v17
    v_exp_f32 v18, v18
    v_exp_f32 v19, v19
    v_smfmac_f32_32x32x32_bf16 v[40:55], a[112:115], v[8:15], v6
    v_exp_f32 v20, v20
    v_exp_f32 v21, v21
    v_exp_f32 v22, v22
    v_exp_f32 v23, v23
    v_exp_f32 v24, v24
    v_exp_f32 v25, v25
    v_smfmac_f32_32x32x32_bf16 v[40:55], a[116:119], v[16:23], v6
    s_waitcnt lgkmcnt(0)
    v_exp_f32 v26, v26
    v_exp_f32 v27, v27
    v_exp_f32 v28, v28
    v_mfma_f32_32x32x16_bf16 v[8:23], v[64:67], v[56:59], 0
    v_exp_f32 v29, v29
    v_exp_f32 v30, v30
    v_exp_f32 v31, v31
    v_exp_f32 v32, v32
    v_exp_f32 v33, v33
    v_exp_f32 v34, v34
    v_exp_f32 v35, v35
    v_smfmac_f32_32x32x32_bf16 v[40:55], a[120:123], v[24:31], v6
    v_exp_f32 v36, v36
    v_exp_f32 v37, v37
    v_exp_f32 v38, v38
    v_exp_f32 v39, v39
    v_exp_f32 v8, v8
    v_exp_f32 v9, v9
    v_smfmac_f32_32x32x32_bf16 v[40:55], a[124:127], v[32:39], v6
    v_exp_f32 v10, v10
    v_exp_f32 v11, v11
    v_exp_f32 v12, v12
    v_exp_f32 v13, v13
    v_mfma_f32_32x32x16_bf16 v[24:39], v[68:71], v[56:59], 0
    ds_write_addtid_b32 v40 offset:9216
    ds_write_addtid_b32 v41 offset:9472
    ds_write_addtid_b32 v42 offset:9728
    ds_write_addtid_b32 v43 offset:9984
    ds_write_addtid_b32 v44 offset:10240
    ds_write_addtid_b32 v45 offset:10496
    ds_write_addtid_b32 v46 offset:10752
    ds_write_addtid_b32 v47 offset:11008
    ds_write_addtid_b32 v48 offset:11264
    v_mfma_f32_32x32x8_bf16 v[40:55], v[60:61], v[60:61], 0
    v_exp_f32 v14, v14
    v_exp_f32 v15, v15
    v_exp_f32 v16, v16
    v_exp_f32 v17, v17
    v_exp_f32 v18, v18
    v_exp_f32 v19, v19
    v_smfmac_f32_32x32x32_bf16 v[40:55], a[0:3], v[8:15], v6
    v_exp_f32 v20, v20
    v_exp_f32 v21, v21
    v_exp_f32 v22, v22
    v_exp_f32 v23, v23
    v_exp_f32 v24, v24
    v_exp_f32 v25, v25
    v_smfmac_f32_32x32x32_bf16 v[40:55], a[4:7], v[16:23], v6
    v_exp_f32 v26, v26
    v_exp_f32 v27, v27
    v_exp_f32 v28, v28
    v_mfma_f32_32x32x16_bf16 v[8:23], v[72:75], v[56:59], 0
    v_exp_f32 v29, v29
    v_exp_f32 v30, v30
    v_exp_f32 v31, v31
    v_exp_f32 v32, v32
    v_exp_f32 v33, v33
    v_exp_f32 v34, v34
    v_exp_f32 v35, v35
    v_smfmac_f32_32x32x32_bf16 v[40:55], a[8:11], v[24:31], v6
    v_exp_f32 v36, v36
    v_exp_f32 v37, v37
    v_exp_f32 v38, v38
    v_exp_f32 v39, v39
    v_exp_f32 v8, v8
    v_exp_f32 v9, v9
    v_smfmac_f32_32x32x32_bf16 v[40:55], a[12:15], v[32:39], v6
    v_exp_f32 v10, v10
    v_exp_f32 v11, v11
    v_exp_f32 v12, v12
    v_mfma_f32_32x32x16_bf16 v[24:39], v[76:79], v[56:59], 0
    v_exp_f32 v13, v13
    v_exp_f32 v14, v14
    v_exp_f32 v15, v15
    v_exp_f32 v16, v16
    v_exp_f32 v17, v17
    v_exp_f32 v18, v18
    v_exp_f32 v19, v19
    v_smfmac_f32_32x32x32_bf16 v[40:55], a[16:19], v[8:15], v6
    v_exp_f32 v20, v20
    v_exp_f32 v21, v21
    v_exp_f32 v22, v22
    v_exp_f32 v23, v23
    v_exp_f32 v24, v24
    v_exp_f32 v25, v25
    v_smfmac_f32_32x32x32_bf16 v[40:55], a[20:23], v[16:23], v6
L_pg1:
    s_cbranch_execz L_wret
    v_exp_f32 v26, v26
    v_exp_f32 v27, v27
    v_exp_f32 v28, v28
    v_mfma_f32_32x32x16_bf16 v[8:23], v[80:83], v[56:59], 0
    v_exp_f32 v29, v29
    v_exp_f32 v30, v30
    v_exp_f32 v31, v31
    v_exp_f32 v32, v32
    v_exp_f32 v33, v33
    v_exp_f32 v34, v34
    v_exp_f32 v35, v35
    v_smfmac_f32_32x32x32_bf16 v[40:55], a[24:27], v[24:31], v6
    v_exp_f32 v36, v36
    v_exp_f32 v37, v37
    v_exp_f32 v38, v38
    v_exp_f32 v39, v39
    v_exp_f32 v8, v8
    v_exp_f32 v9, v9
    v_smfmac_f32_32x32x32_bf16 v[40:55], a[28:31], v[32:39], v6
    v_exp_f32 v10, v10
    v_exp_f32 v11, v11
    v_exp_f32 v12, v12
    v_mfma_f32_32x32x16_bf16 v[24:39], v[84:87], v[56:59], 0
    v_exp_f32 v13, v13
    v_exp_f32 v14, v14
    v_exp_f32 v15, v15
    v_exp_f32 v16, v16
    v_exp_f32 v17, v17
    v_exp_f32 v18, v18
    v_exp_f32 v19, v19
    v_smfmac_f32_32x32x32_bf16 v[40:55], a[32:35], v[8:15], v6
    v_exp_f32 v20, v20
    v_exp_f32 v21, v21
    v_exp_f32 v22, v22
    v_exp_f32 v23, v23
    v_exp_f32 v24, v24
    v_exp_f32 v25, v25
    v_smfmac_f32_32x32x32_bf16 v[40:55], a[36:39], v[16:23], v6
    v_exp_f32 v26, v26
    v_exp_f32 v27, v27
    v_exp_f32 v28, v28
    v_mfma_f32_32x32x16_bf16 v[8:23], v[88:91], v[56:59], 0
    v_exp_f32 v29, v29
    v_exp_f32 v30, v30
    v_exp_f32 v31, v31
    v_exp_f32 v32, v32
    v_exp_f32 v33, v33
    v_exp_f32 v34, v34
    v_exp_f32 v35, v35
    v_smfmac_f32_32x32x32_bf16 v[40:55], a[40:43], v[24:31], v6
    v_exp_f32 v36, v36
    v_exp_f32 v37, v37
    v_exp_f32 v38, v38
    v_exp_f32 v39, v39
    v_exp_f32 v8, v8
    v_exp_f32 v9, v9
    v_smfmac_f32_32x32x32_bf16 v[40:55], a[44:47], v[32:39], v6
    v_exp_f32 v10, v10
    v_exp_f32 v11, v11
    v_exp_f32 v12, v12
    v_mfma_f32_32x32x16_bf16 v[24:39], v[92:95], v[56:59], 0
    v_exp_f32 v13, v13
    v_exp_f32 v14, v14
    v_exp_f32 v15, v15
    v_exp_f32 v16, v16
    v_exp_f32 v17, v17
    v_exp_f32 v18, v18
    v_exp_f32 v19, v19
    v_smfmac_f32_32x32x32_bf16 v[40:55], a[48:51], v[8:15], v6
    v_exp_f32 v20, v20
    v_exp_f32 v21, v21
    v_exp_f32 v22, v22
    v_exp_f32 v23, v23
    v_exp_f32 v24, v24
    v_exp_f32 v25, v25
    v_smfmac_f32_32x32x32_bf16 v[40:55], a[52:55], v[16:23], v6
    v_exp_f32 v26, v26
    v_exp_f32 v27, v27
    v_exp_f32 v28, v28
    v_mfma_f32_32x32x16_bf16 v[8:23], v[96:99], v[56:59], 0
    v_exp_f32 v29, v29
    v_exp_f32 v30, v30
    v_exp_f32 v31, v31
    v_exp_f32 v32, v32
    v_exp_f32 v33, v33
    v_exp_f32 v34, v34
    v_exp_f32 v35, v35
    v_smfmac_f32_32x32x32_bf16 v[40:55], a[56:59], v[24:31], v6
    v_exp_f32 v36, v36
    v_exp_f32 v37, v37
    v_exp_f32 v38, v38
    v_exp_f32 v39, v39
    v_exp_f32 v8, v8
    v_exp_f32 v9, v9
    v_smfmac_f32_32x32x32_bf16 v[40:55], a[60:63], v[32:39], v6
    v_exp_f32 v10, v10
    v_exp_f32 v11, v11
    v_exp_f32 v12, v12
    v_mfma_f32_32x32x16_bf16 v[24:39], v[100:103], v[56:59], 0
    v_exp_f32 v13, v13
    v_exp_f32 v14, v14
    v_exp_f32 v15, v15
    v_exp_f32 v16, v16
    v_exp_f32 v17, v17
    v_exp_f32 v18, v18
    v_exp_f32 v19, v19
    v_smfmac_f32_32x32x32_bf16 v[40:55], a[64:67], v[8:15], v6
    v_exp_f32 v20, v20
    v_exp_f32 v21, v21
    v_exp_f32 v22, v22
    v_exp_f32 v23, v23
    v_exp_f32 v24, v24
    v_exp_f32 v25, v25
    v_smfmac_f32_32x32x32_bf16 v[40:55], a[68:71], v[16:23], v6
    v_exp_f32 v26, v26
    v_exp_f32 v27, v27
    v_exp_f32 v28, v28
    v_mfma_f32_32x32x16_bf16 v[8:23], v[104:107], v[56:59], 0
    v_exp_f32 v29, v29
    v_exp_f32 v30, v30
    v_exp_f32 v31, v31
    v_exp_f32 v32, v32
    v_exp_f32 v33, v33
    v_exp_f32 v34, v34
    v_exp_f32 v35, v35
    v_smfmac_f32_32x32x32_bf16 v[40:55], a[72:75], v[24:31], v6
    v_exp_f32 v36, v36
    v_exp_f32 v37, v37
    v_exp_f32 v38, v38
    v_exp_f32 v39, v39
    v_exp_f32 v8, v8
    v_exp_f32 v9, v9
    v_smfmac_f32_32x32x32_bf16 v[40:55], a[76:79], v[32:39], v6
    v_exp_f32 v10, v10
    v_exp_f32 v11, v11
    v_exp_f32 v12, v12
    v_mfma_f32_32x32x16_bf16 v[24:39], v[108:111], v[56:59], 0
    v_exp_f32 v13, v13
    v_exp_f32 v14, v14
    v_exp_f32 v15, v15
    v_exp_f32 v16, v16
    v_exp_f32 v17, v17
    v_exp_f32 v18, v18
    v_exp_f32 v19, v19
    v_smfmac_f32_32x32x32_bf16 v[40:55], a[80:83], v[8:15], v6
    v_exp_f32 v20, v20
    v_exp_f32 v21, v21
    v_exp_f32 v22, v22
    v_exp_f32 v23, v23
    v_exp_f32 v24, v24
    v_exp_f32 v25, v25
    v_smfmac_f32_32x32x32_bf16 v[40:55], a[84:87], v[16:23], v6
    v_exp_f32 v26, v26
    v_exp_f32 v27, v27
    v_exp_f32 v28, v28
    v_mfma_f32_32x32x16_bf16 v[8:23], v[112:115], v[56:59], 0
    v_exp_f32 v29, v29
    v_exp_f32 v30, v30
    v_exp_f32 v31, v31
    v_exp_f32 v32, v32
    v_exp_f32 v33, v33
    v_exp_f32 v34, v34
    v_exp_f32 v35, v35
    v_smfmac_f32_32x32x32_bf16 v[40:55], a[88:91], v[24:31], v6
    v_exp_f32 v36, v36
    v_exp_f32 v37, v37
    v_exp_f32 v38, v38
    v_exp_f32 v39, v39
    v_exp_f32 v8, v8
    v_exp_f32 v9, v9
    v_smfmac_f32_32x32x32_bf16 v[40:55], a[92:95], v[32:39], v6
    v_exp_f32 v10, v10
    v_exp_f32 v11, v11
    v_exp_f32 v12, v12
    v_mfma_f32_32x32x16_bf16 v[24:39], v[116:119], v[56:59], 0
    v_exp_f32 v13, v13
    v_exp_f32 v14, v14
    v_exp_f32 v15, v15
    v_exp_f32 v16, v16
    v_exp_f32 v17, v17
    v_exp_f32 v18, v18
    v_exp_f32 v19, v19
    v_smfmac_f32_32x32x32_bf16 v[40:55], a[96:99], v[8:15], v6
    v_exp_f32 v20, v20
    v_exp_f32 v21, v21
    v_exp_f32 v22, v22
    v_exp_f32 v23, v23
    v_exp_f32 v24, v24
    v_exp_f32 v25, v25
    v_smfmac_f32_32x32x32_bf16 v[40:55], a[100:103], v[16:23], v6
    v_exp_f32 v26, v26
    v_exp_f32 v27, v27
    v_exp_f32 v28, v28
    v_mfma_f32_32x32x16_bf16 v[8:23], v[120:123], v[56:59], 0
    v_exp_f32 v29, v29
    v_exp_f32 v30, v30
    v_exp_f32 v31, v31
    v_exp_f32 v32, v32
    v_exp_f32 v33, v33
    v_exp_f32 v34, v34
    v_exp_f32 v35, v35
    v_smfmac_f32_32x32x32_bf16 v[40:55], a[104:107], v[24:31], v6
    v_exp_f32 v36, v36
    v_exp_f32 v37, v37
    v_exp_f32 v38, v38
    v_exp_f32 v39, v39
    v_exp_f32 v8, v8
    v_exp_f32 v9, v9
    v_smfmac_f32_32x32x32_bf16 v[40:55], a[108:111], v[32:39], v6
    v_exp_f32 v10, v10
    v_exp_f32 v11, v11
    v_exp_f32 v12, v12
    v_mfma_f32_32x32x16_bf16 v[24:39], v[124:127], v[56:59], 0
    ds_read_b128 v[56:59], v3 offset:3072
    ds_read_b32 v63, v62 offset:2048
    v_exp_f32 v13, v13
    v_exp_f32 v14, v14
    v_exp_f32 v15, v15
    v_exp_f32 v16, v16
    v_exp_f32 v17, v17
    v_exp_f32 v18, v18
    v_exp_f32 v19, v19
    v_smfmac_f32_32x32x32_bf16 v[40:55], a[112:115], v[8:15], v6
    v_exp_f32 v20, v20
    v_exp_f32 v21, v21
    v_exp_f32 v22, v22
    v_exp_f32 v23, v23
    v_exp_f32 v24, v24
    v_exp_f32 v25, v25
    v_smfmac_f32_32x32x32_bf16 v[40:55], a[116:119], v[16:23], v6
    s_waitcnt lgkmcnt(0)
    v_exp_f32 v26, v26
    v_exp_f32 v27, v27
    v_exp_f32 v28, v28
    v_mfma_f32_32x32x16_bf16 v[8:23], v[64:67], v[56:59], 0
    v_cmp_neq_f32 vcc, -1.0, v63
    v_exp_f32 v29, v29
    v_exp_f32 v30, v30
    v_exp_f32 v31, v31
    v_exp_f32 v32, v32
    v_exp_f32 v33, v33
    v_exp_f32 v34, v34
    v_exp_f32 v35, v35
    v_smfmac_f32_32x32x32_bf16 v[40:55], a[120:123], v[24:31], v6
    v_exp_f32 v36, v36
    v_exp_f32 v37, v37
    v_exp_f32 v38, v38
    v_exp_f32 v39, v39
    v_exp_f32 v8, v8
    v_exp_f32 v9, v9
    v_smfmac_f32_32x32x32_bf16 v[40:55], a[124:127], v[32:39], v6
    s_cbranch_vccnz L_aw2
L_ag2:
    v_exp_f32 v10, v10
    v_exp_f32 v11, v11
    v_exp_f32 v12, v12
    v_exp_f32 v13, v13
    v_mfma_f32_32x32x16_bf16 v[24:39], v[68:71], v[56:59], 0
    ds_write_addtid_b32 v40 offset:0
    ds_write_addtid_b32 v41 offset:256
    ds_write_addtid_b32 v42 offset:512
    ds_write_addtid_b32 v43 offset:768
    ds_write_addtid_b32 v44 offset:1024
    ds_write_addtid_b32 v45 offset:1280
    ds_write_addtid_b32 v46 offset:1536
    ds_write_addtid_b32 v47 offset:1792
    ds_write_addtid_b32 v48 offset:2048
    v_mfma_f32_32x32x8_bf16 v[40:55], v[60:61], v[60:61], 0
    v_exp_f32 v14, v14
    v_exp_f32 v15, v15
    v_exp_f32 v16, v16
    v_exp_f32 v17, v17
    v_exp_f32 v18, v18
    v_exp_f32 v19, v19
    v_smfmac_f32_32x32x32_bf16 v[40:55], a[0:3], v[8:15], v6
    v_exp_f32 v20, v20
    v_exp_f32 v21, v21
    v_exp_f32 v22, v22
    v_exp_f32 v23, v23
    v_exp_f32 v24, v24
    v_exp_f32 v25, v25
    v_smfmac_f32_32x32x32_bf16 v[40:55], a[4:7], v[16:23], v6
    v_exp_f32 v26, v26
    v_exp_f32 v27, v27
    v_exp_f32 v28, v28
    v_mfma_f32_32x32x16_bf16 v[8:23], v[72:75], v[56:59], 0
    v_exp_f32 v29, v29
    v_exp_f32 v30, v30
    v_exp_f32 v31, v31
    v_exp_f32 v32, v32
    v_exp_f32 v33, v33
    v_exp_f32 v34, v34
    v_exp_f32 v35, v35
    v_smfmac_f32_32x32x32_bf16 v[40:55], a[8:11], v[24:31], v6
    v_exp_f32 v36, v36
    v_exp_f32 v37, v37
    v_exp_f32 v38, v38
    v_exp_f32 v39, v39
    v_exp_f32 v8, v8
    v_exp_f32 v9, v9
    v_smfmac_f32_32x32x32_bf16 v[40:55], a[12:15], v[32:39], v6
    v_exp_f32 v10, v10
    v_exp_f32 v11, v11
    v_exp_f32 v12, v12
    v_mfma_f32_32x32x16_bf16 v[24:39], v[76:79], v[56:59], 0
    v_exp_f32 v13, v13
    v_exp_f32 v14, v14
    v_exp_f32 v15, v15
    v_exp_f32 v16, v16
    v_exp_f32 v17, v17
    v_exp_f32 v18, v18
    v_exp_f32 v19, v19
    v_smfmac_f32_32x32x32_bf16 v[40:55], a[16:19], v[8:15], v6
    v_exp_f32 v20, v20
    v_exp_f32 v21, v21
    v_exp_f32 v22, v22
    v_exp_f32 v23, v23
    v_exp_f32 v24, v24
    v_exp_f32 v25, v25
    v_smfmac_f32_32x32x32_bf16 v[40:55], a[20:23], v[16:23], v6
    v_exp_f32 v26, v26
    v_exp_f32 v27, v27
    v_exp_f32 v28, v28
    v_mfma_f32_32x32x16_bf16 v[8:23], v[80:83], v[56:59], 0
    v_exp_f32 v29, v29
    v_exp_f32 v30, v30
    v_exp_f32 v31, v31
    v_exp_f32 v32, v32
    v_exp_f32 v33, v33
    v_exp_f32 v34, v34
    v_exp_f32 v35, v35
    v_smfmac_f32_32x32x32_bf16 v[40:55], a[24:27], v[24:31], v6
    v_exp_f32 v36, v36
    v_exp_f32 v37, v37
    v_exp_f32 v38, v38
    v_exp_f32 v39, v39
    v_exp_f32 v8, v8
    v_exp_f32 v9, v9
    v_smfmac_f32_32x32x32_bf16 v[40:55], a[28:31], v[32:39], v6
    v_exp_f32 v10, v10
    v_exp_f32 v11, v11
    v_exp_f32 v12, v12
    v_mfma_f32_32x32x16_bf16 v[24:39], v[84:87], v[56:59], 0
    v_exp_f32 v13, v13
    v_exp_f32 v14, v14
    v_exp_f32 v15, v15
    v_exp_f32 v16, v16
    v_exp_f32 v17, v17
    v_exp_f32 v18, v18
    v_exp_f32 v19, v19
    v_smfmac_f32_32x32x32_bf16 v[40:55], a[32:35], v[8:15], v6
    v_exp_f32 v20, v20
    v_exp_f32 v21, v21
    v_exp_f32 v22, v22
    v_exp_f32 v23, v23
    v_exp_f32 v24, v24
    v_exp_f32 v25, v25
    v_smfmac_f32_32x32x32_bf16 v[40:55], a[36:39], v[16:23], v6
    v_exp_f32 v26, v26
    v_exp_f32 v27, v27
    v_exp_f32 v28, v28
    v_mfma_f32_32x32x16_bf16 v[8:23], v[88:91], v[56:59], 0
    v_exp_f32 v29, v29
    v_exp_f32 v30, v30
    v_exp_f32 v31, v31
    v_exp_f32 v32, v32
    v_exp_f32 v33, v33
    v_exp_f32 v34, v34
    v_exp_f32 v35, v35
    v_smfmac_f32_32x32x32_bf16 v[40:55], a[40:43], v[24:31], v6
    v_exp_f32 v36, v36
    v_exp_f32 v37, v37
    v_exp_f32 v38, v38
    v_exp_f32 v39, v39
    v_exp_f32 v8, v8
    v_exp_f32 v9, v9
    v_smfmac_f32_32x32x32_bf16 v[40:55], a[44:47], v[32:39], v6
    v_exp_f32 v10, v10
    v_exp_f32 v11, v11
    v_exp_f32 v12, v12
    v_mfma_f32_32x32x16_bf16 v[24:39], v[92:95], v[56:59], 0
    v_exp_f32 v13, v13
    v_exp_f32 v14, v14
    v_exp_f32 v15, v15
    v_exp_f32 v16, v16
    v_exp_f32 v17, v17
    v_exp_f32 v18, v18
    v_exp_f32 v19, v19
    v_smfmac_f32_32x32x32_bf16 v[40:55], a[48:51], v[8:15], v6
    v_exp_f32 v20, v20
    v_exp_f32 v21, v21
    v_exp_f32 v22, v22
    v_exp_f32 v23, v23
    v_exp_f32 v24, v24
    v_exp_f32 v25, v25
    v_smfmac_f32_32x32x32_bf16 v[40:55], a[52:55], v[16:23], v6
    v_exp_f32 v26, v26
    v_exp_f32 v27, v27
    v_exp_f32 v28, v28
    v_mfma_f32_32x32x16_bf16 v[8:23], v[96:99], v[56:59], 0
    v_exp_f32 v29, v29
    v_exp_f32 v30, v30
    v_exp_f32 v31, v31
    v_exp_f32 v32, v32
    v_exp_f32 v33, v33
    v_exp_f32 v34, v34
    v_exp_f32 v35, v35
    v_smfmac_f32_32x32x32_bf16 v[40:55], a[56:59], v[24:31], v6
    v_exp_f32 v36, v36
    v_exp_f32 v37, v37
    v_exp_f32 v38, v38
    v_exp_f32 v39, v39
    v_exp_f32 v8, v8
    v_exp_f32 v9, v9
    v_smfmac_f32_32x32x32_bf16 v[40:55], a[60:63], v[32:39], v6
    v_exp_f32 v10, v10
    v_exp_f32 v11, v11
    v_exp_f32 v12, v12
    v_mfma_f32_32x32x16_bf16 v[24:39], v[100:103], v[56:59], 0
    v_exp_f32 v13, v13
    v_exp_f32 v14, v14
    v_exp_f32 v15, v15
    v_exp_f32 v16, v16
    v_exp_f32 v17, v17
    v_exp_f32 v18, v18
    v_exp_f32 v19, v19
    v_smfmac_f32_32x32x32_bf16 v[40:55], a[64:67], v[8:15], v6
    v_exp_f32 v20, v20
    v_exp_f32 v21, v21
    v_exp_f32 v22, v22
    v_exp_f32 v23, v23
    v_exp_f32 v24, v24
    v_exp_f32 v25, v25
    v_smfmac_f32_32x32x32_bf16 v[40:55], a[68:71], v[16:23], v6
    v_exp_f32 v26, v26
    v_exp_f32 v27, v27
    v_exp_f32 v28, v28
    v_mfma_f32_32x32x16_bf16 v[8:23], v[104:107], v[56:59], 0
    v_exp_f32 v29, v29
    v_exp_f32 v30, v30
    v_exp_f32 v31, v31
    v_exp_f32 v32, v32
    v_exp_f32 v33, v33
    v_exp_f32 v34, v34
    v_exp_f32 v35, v35
    v_smfmac_f32_32x32x32_bf16 v[40:55], a[72:75], v[24:31], v6
    v_exp_f32 v36, v36
    v_exp_f32 v37, v37
    v_exp_f32 v38, v38
    v_exp_f32 v39, v39
    v_exp_f32 v8, v8
    v_exp_f32 v9, v9
    v_smfmac_f32_32x32x32_bf16 v[40:55], a[76:79], v[32:39], v6
    v_exp_f32 v10, v10
    v_exp_f32 v11, v11
    v_exp_f32 v12, v12
    v_mfma_f32_32x32x16_bf16 v[24:39], v[108:111], v[56:59], 0
    v_exp_f32 v13, v13
    v_exp_f32 v14, v14
    v_exp_f32 v15, v15
    v_exp_f32 v16, v16
    v_exp_f32 v17, v17
    v_exp_f32 v18, v18
    v_exp_f32 v19, v19
    v_smfmac_f32_32x32x32_bf16 v[40:55], a[80:83], v[8:15], v6
    v_exp_f32 v20, v20
    v_exp_f32 v21, v21
    v_exp_f32 v22, v22
    v_exp_f32 v23, v23
    v_exp_f32 v24, v24
    v_exp_f32 v25, v25
    v_smfmac_f32_32x32x32_bf16 v[40:55], a[84:87], v[16:23], v6
    v_exp_f32 v26, v26
    v_exp_f32 v27, v27
    v_exp_f32 v28, v28
    v_mfma_f32_32x32x16_bf16 v[8:23], v[112:115], v[56:59], 0
    v_exp_f32 v29, v29
    v_exp_f32 v30, v30
    v_exp_f32 v31, v31
    v_exp_f32 v32, v32
    v_exp_f32 v33, v33
    v_exp_f32 v34, v34
    v_exp_f32 v35, v35
    v_smfmac_f32_32x32x32_bf16 v[40:55], a[88:91], v[24:31], v6
    v_exp_f32 v36, v36
    v_exp_f32 v37, v37
    v_exp_f32 v38, v38
    v_exp_f32 v39, v39
    v_exp_f32 v8, v8
    v_exp_f32 v9, v9
    v_smfmac_f32_32x32x32_bf16 v[40:55], a[92:95], v[32:39], v6
    v_exp_f32 v10, v10
    v_exp_f32 v11, v11
    v_exp_f32 v12, v12
    v_mfma_f32_32x32x16_bf16 v[24:39], v[116:119], v[56:59], 0
    v_exp_f32 v13, v13
    v_exp_f32 v14, v14
    v_exp_f32 v15, v15
    v_exp_f32 v16, v16
    v_exp_f32 v17, v17
    v_exp_f32 v18, v18
    v_exp_f32 v19, v19
    v_smfmac_f32_32x32x32_bf16 v[40:55], a[96:99], v[8:15], v6
    v_exp_f32 v20, v20
    v_exp_f32 v21, v21
    v_exp_f32 v22, v22
    v_exp_f32 v23, v23
    v_exp_f32 v24, v24
    v_exp_f32 v25, v25
    v_smfmac_f32_32x32x32_bf16 v[40:55], a[100:103], v[16:23], v6
    v_exp_f32 v26, v26
    v_exp_f32 v27, v27
    v_exp_f32 v28, v28
    v_mfma_f32_32x32x16_bf16 v[8:23], v[120:123], v[56:59], 0
    v_exp_f32 v29, v29
    v_exp_f32 v30, v30
    v_exp_f32 v31, v31
    v_exp_f32 v32, v32
    v_exp_f32 v33, v33
    v_exp_f32 v34, v34
    v_exp_f32 v35, v35
    v_smfmac_f32_32x32x32_bf16 v[40:55], a[104:107], v[24:31], v6
    v_exp_f32 v36, v36
    v_exp_f32 v37, v37
    v_exp_f32 v38, v38
    v_exp_f32 v39, v39
    v_exp_f32 v8, v8
    v_exp_f32 v9, v9
    v_smfmac_f32_32x32x32_bf16 v[40:55], a[108:111], v[32:39], v6
    v_exp_f32 v10, v10
    v_exp_f32 v11, v11
    v_exp_f32 v12, v12
    v_mfma_f32_32x32x16_bf16 v[24:39], v[124:127], v[56:59], 0
    ds_read_b128 v[56:59], v3 offset:4096
    ds_read_b32 v63, v62 offset:11264
    v_exp_f32 v13, v13
    v_exp_f32 v14, v14
    v_exp_f32 v15, v15
    v_exp_f32 v16, v16
    v_exp_f32 v17, v17
    v_exp_f32 v18, v18
    v_exp_f32 v19, v19
    v_smfmac_f32_32x32x32_bf16 v[40:55], a[112:115], v[8:15], v6
    v_exp_f32 v20, v20
    v_exp_f32 v21, v21
    v_exp_f32 v22, v22
    v_exp_f32 v23, v23
    v_exp_f32 v24, v24
    v_exp_f32 v25, v25
    v_smfmac_f32_32x32x32_bf16 v[40:55], a[116:119], v[16:23], v6
    s_waitcnt lgkmcnt(0)
    v_exp_f32 v26, v26
    v_exp_f32 v27, v27
    v_exp_f32 v28, v28
    v_mfma_f32_32x32x16_bf16 v[8:23], v[64:67], v[56:59], 0
    v_cmp_neq_f32 vcc, -1.0, v63
    v_exp_f32 v29, v29
    v_exp_f32 v30, v30
    v_exp_f32 v31, v31
    v_exp_f32 v32, v32
    v_exp_f32 v33, v33
    v_exp_f32 v34, v34
    v_exp_f32 v35, v35
    v_smfmac_f32_32x32x32_bf16 v[40:55], a[120:123], v[24:31], v6
    v_exp_f32 v36, v36
    v_exp_f32 v37, v37
    v_exp_f32 v38, v38
    v_exp_f32 v39, v39
    v_exp_f32 v8, v8
    v_exp_f32 v9, v9
    v_smfmac_f32_32x32x32_bf16 v[40:55], a[124:127], v[32:39], v6
    s_cbranch_vccnz L_aw3
L_ag3:
    v_exp_f32 v10, v10
    v_exp_f32 v11, v11
    v_exp_f32 v12, v12
    v_exp_f32 v13, v13
    v_mfma_f32_32x32x16_bf16 v[24:39], v[68:71], v[56:59], 0
    ds_write_addtid_b32 v40 offset:9216
    ds_write_addtid_b32 v41 offset:9472
    ds_write_addtid_b32 v42 offset:9728
    ds_write_addtid_b32 v43 offset:9984
    ds_write_addtid_b32 v44 offset:10240
    ds_write_addtid_b32 v45 offset:10496
    ds_write_addtid_b32 v46 offset:10752
    ds_write_addtid_b32 v47 offset:11008
    ds_write_addtid_b32 v48 offset:11264
    v_mfma_f32_32x32x8_bf16 v[40:55], v[60:61], v[60:61], 0
    v_exp_f32 v14, v14
    v_exp_f32 v15, v15
    v_exp_f32 v16, v16
    v_exp_f32 v17, v17
    v_exp_f32 v18, v18
    v_exp_f32 v19, v19
    v_smfmac_f32_32x32x32_bf16 v[40:55], a[0:3], v[8:15], v6
    v_exp_f32 v20, v20
    v_exp_f32 v21, v21
    v_exp_f32 v22, v22
    v_exp_f32 v23, v23
    v_exp_f32 v24, v24
    v_exp_f32 v25, v25
    v_smfmac_f32_32x32x32_bf16 v[40:55], a[4:7], v[16:23], v6
    v_exp_f32 v26, v26
    v_exp_f32 v27, v27
    v_exp_f32 v28, v28
    v_mfma_f32_32x32x16_bf16 v[8:23], v[72:75], v[56:59], 0
    v_exp_f32 v29, v29
    v_exp_f32 v30, v30
    v_exp_f32 v31, v31
    v_exp_f32 v32, v32
    v_exp_f32 v33, v33
    v_exp_f32 v34, v34
    v_exp_f32 v35, v35
    v_smfmac_f32_32x32x32_bf16 v[40:55], a[8:11], v[24:31], v6
    v_exp_f32 v36, v36
    v_exp_f32 v37, v37
    v_exp_f32 v38, v38
    v_exp_f32 v39, v39
    v_exp_f32 v8, v8
    v_exp_f32 v9, v9
    v_smfmac_f32_32x32x32_bf16 v[40:55], a[12:15], v[32:39], v6
    v_exp_f32 v10, v10
    v_exp_f32 v11, v11
    v_exp_f32 v12, v12
    v_mfma_f32_32x32x16_bf16 v[24:39], v[76:79], v[56:59], 0
    v_exp_f32 v13, v13
    v_exp_f32 v14, v14
    v_exp_f32 v15, v15
    v_exp_f32 v16, v16
    v_exp_f32 v17, v17
    v_exp_f32 v18, v18
    v_exp_f32 v19, v19
    v_smfmac_f32_32x32x32_bf16 v[40:55], a[16:19], v[8:15], v6
    v_exp_f32 v20, v20
    v_exp_f32 v21, v21
    v_exp_f32 v22, v22
    v_exp_f32 v23, v23
    v_exp_f32 v24, v24
    v_exp_f32 v25, v25
    v_smfmac_f32_32x32x32_bf16 v[40:55], a[20:23], v[16:23], v6
    v_exp_f32 v26, v26
    v_exp_f32 v27, v27
    v_exp_f32 v28, v28
    v_mfma_f32_32x32x16_bf16 v[8:23], v[80:83], v[56:59], 0
    v_exp_f32 v29, v29
    v_exp_f32 v30, v30
    v_exp_f32 v31, v31
    v_exp_f32 v32, v32
    v_exp_f32 v33, v33
    v_exp_f32 v34, v34
    v_exp_f32 v35, v35
    v_smfmac_f32_32x32x32_bf16 v[40:55], a[24:27], v[24:31], v6
    v_exp_f32 v36, v36
    v_exp_f32 v37, v37
    v_exp_f32 v38, v38
    v_exp_f32 v39, v39
    v_exp_f32 v8, v8
    v_exp_f32 v9, v9
    v_smfmac_f32_32x32x32_bf16 v[40:55], a[28:31], v[32:39], v6
    v_exp_f32 v10, v10
    v_exp_f32 v11, v11
    v_exp_f32 v12, v12
    v_mfma_f32_32x32x16_bf16 v[24:39], v[84:87], v[56:59], 0
    v_exp_f32 v13, v13
    v_exp_f32 v14, v14
    v_exp_f32 v15, v15
    v_exp_f32 v16, v16
    v_exp_f32 v17, v17
    v_exp_f32 v18, v18
    v_exp_f32 v19, v19
    v_smfmac_f32_32x32x32_bf16 v[40:55], a[32:35], v[8:15], v6
    v_exp_f32 v20, v20
    v_exp_f32 v21, v21
    v_exp_f32 v22, v22
    v_exp_f32 v23, v23
    v_exp_f32 v24, v24
    v_exp_f32 v25, v25
    v_smfmac_f32_32x32x32_bf16 v[40:55], a[36:39], v[16:23], v6
    v_exp_f32 v26, v26
    v_exp_f32 v27, v27
    v_exp_f32 v28, v28
    v_mfma_f32_32x32x16_bf16 v[8:23], v[88:91], v[56:59], 0
    v_exp_f32 v29, v29
    v_exp_f32 v30, v30
    v_exp_f32 v31, v31
    v_exp_f32 v32, v32
    v_exp_f32 v33, v33
    v_exp_f32 v34, v34
    v_exp_f32 v35, v35
    v_smfmac_f32_32x32x32_bf16 v[40:55], a[40:43], v[24:31], v6
    v_exp_f32 v36, v36
    v_exp_f32 v37, v37
    v_exp_f32 v38, v38
    v_exp_f32 v39, v39
    v_exp_f32 v8, v8
    v_exp_f32 v9, v9
    v_smfmac_f32_32x32x32_bf16 v[40:55], a[44:47], v[32:39], v6
    v_exp_f32 v10, v10
    v_exp_f32 v11, v11
    v_exp_f32 v12, v12
    v_mfma_f32_32x32x16_bf16 v[24:39], v[92:95], v[56:59], 0
    v_exp_f32 v13, v13
    v_exp_f32 v14, v14
    v_exp_f32 v15, v15
    v_exp_f32 v16, v16
    v_exp_f32 v17, v17
    v_exp_f32 v18, v18
    v_exp_f32 v19, v19
    v_smfmac_f32_32x32x32_bf16 v[40:55], a[48:51], v[8:15], v6
    v_exp_f32 v20, v20
    v_exp_f32 v21, v21
    v_exp_f32 v22, v22
    v_exp_f32 v23, v23
    v_exp_f32 v24, v24
    v_exp_f32 v25, v25
    v_smfmac_f32_32x32x32_bf16 v[40:55], a[52:55], v[16:23], v6
    v_exp_f32 v26, v26
    v_exp_f32 v27, v27
    v_exp_f32 v28, v28
    v_mfma_f32_32x32x16_bf16 v[8:23], v[96:99], v[56:59], 0
    v_exp_f32 v29, v29
    v_exp_f32 v30, v30
    v_exp_f32 v31, v31
    v_exp_f32 v32, v32
    v_exp_f32 v33, v33
    v_exp_f32 v34, v34
    v_exp_f32 v35, v35
    v_smfmac_f32_32x32x32_bf16 v[40:55], a[56:59], v[24:31], v6
    v_exp_f32 v36, v36
    v_exp_f32 v37, v37
    v_exp_f32 v38, v38
    v_exp_f32 v39, v39
    v_exp_f32 v8, v8
    v_exp_f32 v9, v9
    v_smfmac_f32_32x32x32_bf16 v[40:55], a[60:63], v[32:39], v6
    v_exp_f32 v10, v10
    v_exp_f32 v11, v11
    v_exp_f32 v12, v12
    v_mfma_f32_32x32x16_bf16 v[24:39], v[100:103], v[56:59], 0
    v_exp_f32 v13, v13
    v_exp_f32 v14, v14
    v_exp_f32 v15, v15
    v_exp_f32 v16, v16
    v_exp_f32 v17, v17
    v_exp_f32 v18, v18
    v_exp_f32 v19, v19
    v_smfmac_f32_32x32x32_bf16 v[40:55], a[64:67], v[8:15], v6
    v_exp_f32 v20, v20
    v_exp_f32 v21, v21
    v_exp_f32 v22, v22
    v_exp_f32 v23, v23
    v_exp_f32 v24, v24
    v_exp_f32 v25, v25
    v_smfmac_f32_32x32x32_bf16 v[40:55], a[68:71], v[16:23], v6
    v_exp_f32 v26, v26
    v_exp_f32 v27, v27
    v_exp_f32 v28, v28
    v_mfma_f32_32x32x16_bf16 v[8:23], v[104:107], v[56:59], 0
    v_exp_f32 v29, v29
    v_exp_f32 v30, v30
    v_exp_f32 v31, v31
    v_exp_f32 v32, v32
    v_exp_f32 v33, v33
    v_exp_f32 v34, v34
    v_exp_f32 v35, v35
    v_smfmac_f32_32x32x32_bf16 v[40:55], a[72:75], v[24:31], v6
    v_exp_f32 v36, v36
    v_exp_f32 v37, v37
    v_exp_f32 v38, v38
    v_exp_f32 v39, v39
    v_exp_f32 v8, v8
    v_exp_f32 v9, v9
    v_smfmac_f32_32x32x32_bf16 v[40:55], a[76:79], v[32:39], v6
    v_exp_f32 v10, v10
    v_exp_f32 v11, v11
    v_exp_f32 v12, v12
    v_mfma_f32_32x32x16_bf16 v[24:39], v[108:111], v[56:59], 0
    v_exp_f32 v13, v13
    v_exp_f32 v14, v14
    v_exp_f32 v15, v15
    v_exp_f32 v16, v16
    v_exp_f32 v17, v17
    v_exp_f32 v18, v18
    v_exp_f32 v19, v19
    v_smfmac_f32_32x32x32_bf16 v[40:55], a[80:83], v[8:15], v6
    v_exp_f32 v20, v20
    v_exp_f32 v21, v21
    v_exp_f32 v22, v22
    v_exp_f32 v23, v23
    v_exp_f32 v24, v24
    v_exp_f32 v25, v25
    v_smfmac_f32_32x32x32_bf16 v[40:55], a[84:87], v[16:23], v6
    v_exp_f32 v26, v26
    v_exp_f32 v27, v27
    v_exp_f32 v28, v28
    v_mfma_f32_32x32x16_bf16 v[8:23], v[112:115], v[56:59], 0
    v_exp_f32 v29, v29
    v_exp_f32 v30, v30
    v_exp_f32 v31, v31
    v_exp_f32 v32, v32
    v_exp_f32 v33, v33
    v_exp_f32 v34, v34
    v_exp_f32 v35, v35
    v_smfmac_f32_32x32x32_bf16 v[40:55], a[88:91], v[24:31], v6
    v_exp_f32 v36, v36
    v_exp_f32 v37, v37
    v_exp_f32 v38, v38
    v_exp_f32 v39, v39
    v_exp_f32 v8, v8
    v_exp_f32 v9, v9
    v_smfmac_f32_32x32x32_bf16 v[40:55], a[92:95], v[32:39], v6
    v_exp_f32 v10, v10
    v_exp_f32 v11, v11
    v_exp_f32 v12, v12
    v_mfma_f32_32x32x16_bf16 v[24:39], v[116:119], v[56:59], 0
    v_exp_f32 v13, v13
    v_exp_f32 v14, v14
    v_exp_f32 v15, v15
    v_exp_f32 v16, v16
    v_exp_f32 v17, v17
    v_exp_f32 v18, v18
    v_exp_f32 v19, v19
    v_smfmac_f32_32x32x32_bf16 v[40:55], a[96:99], v[8:15], v6
    v_exp_f32 v20, v20
    v_exp_f32 v21, v21
    v_exp_f32 v22, v22
    v_exp_f32 v23, v23
    v_exp_f32 v24, v24
    v_exp_f32 v25, v25
    v_smfmac_f32_32x32x32_bf16 v[40:55], a[100:103], v[16:23], v6
    v_exp_f32 v26, v26
    v_exp_f32 v27, v27
    v_exp_f32 v28, v28
    v_mfma_f32_32x32x16_bf16 v[8:23], v[120:123], v[56:59], 0
    v_exp_f32 v29, v29
    v_exp_f32 v30, v30
    v_exp_f32 v31, v31
    v_exp_f32 v32, v32
    v_exp_f32 v33, v33
    v_exp_f32 v34, v34
    v_exp_f32 v35, v35
    v_smfmac_f32_32x32x32_bf16 v[40:55], a[104:107], v[24:31], v6
    v_exp_f32 v36, v36
    v_exp_f32 v37, v37
    v_exp_f32 v38, v38
    v_exp_f32 v39, v39
    v_exp_f32 v8, v8
    v_exp_f32 v9, v9
    v_smfmac_f32_32x32x32_bf16 v[40:55], a[108:111], v[32:39], v6
    v_exp_f32 v10, v10
    v_exp_f32 v11, v11
    v_exp_f32 v12, v12
    v_mfma_f32_32x32x16_bf16 v[24:39], v[124:127], v[56:59], 0
    ds_read_b128 v[56:59], v3 offset:5120
    ds_read_b32 v63, v62 offset:2048
    v_exp_f32 v13, v13
    v_exp_f32 v14, v14
    v_exp_f32 v15, v15
    v_exp_f32 v16, v16
    v_exp_f32 v17, v17
    v_exp_f32 v18, v18
    v_exp_f32 v19, v19
    v_smfmac_f32_32x32x32_bf16 v[40:55], a[112:115], v[8:15], v6
    v_exp_f32 v20, v20
    v_exp_f32 v21, v21
    v_exp_f32 v22, v22
L_pg2:
    s_cbranch_execz L_wret
    v_exp_f32 v23, v23
    v_exp_f32 v24, v24
    v_exp_f32 v25, v25
    v_smfmac_f32_32x32x32_bf16 v[40:55], a[116:119], v[16:23], v6
    s_waitcnt lgkmcnt(0)
    v_exp_f32 v26, v26
    v_exp_f32 v27, v27
    v_exp_f32 v28, v28
    v_mfma_f32_32x32x16_bf16 v[8:23], v[64:67], v[56:59], 0
    v_cmp_neq_f32 vcc, -1.0, v63
    v_exp_f32 v29, v29
    v_exp_f32 v30, v30
    v_exp_f32 v31, v31
    v_exp_f32 v32, v32
    v_exp_f32 v33, v33
    v_exp_f32 v34, v34
    v_exp_f32 v35, v35
    v_smfmac_f32_32x32x32_bf16 v[40:55], a[120:123], v[24:31], v6
    v_exp_f32 v36, v36
    v_exp_f32 v37, v37
    v_exp_f32 v38, v38
    v_exp_f32 v39, v39
    v_exp_f32 v8, v8
    v_exp_f32 v9, v9
    v_smfmac_f32_32x32x32_bf16 v[40:55], a[124:127], v[32:39], v6
    s_cbranch_vccnz L_aw4
L_ag4:
    v_exp_f32 v10, v10
    v_exp_f32 v11, v11
    v_exp_f32 v12, v12
    v_exp_f32 v13, v13
    v_mfma_f32_32x32x16_bf16 v[24:39], v[68:71], v[56:59], 0
    ds_write_addtid_b32 v40 offset:0
    ds_write_addtid_b32 v41 offset:256
    ds_write_addtid_b32 v42 offset:512
    ds_write_addtid_b32 v43 offset:768
    ds_write_addtid_b32 v44 offset:1024
    ds_write_addtid_b32 v45 offset:1280
    ds_write_addtid_b32 v46 offset:1536
    ds_write_addtid_b32 v47 offset:1792
    ds_write_addtid_b32 v48 offset:2048
    v_mfma_f32_32x32x8_bf16 v[40:55], v[60:61], v[60:61], 0
    v_exp_f32 v14, v14
    v_exp_f32 v15, v15
    v_exp_f32 v16, v16
    v_exp_f32 v17, v17
    v_exp_f32 v18, v18
    v_exp_f32 v19, v19
    v_smfmac_f32_32x32x32_bf16 v[40:55], a[0:3], v[8:15], v6
    v_exp_f32 v20, v20
    v_exp_f32 v21, v21
    v_exp_f32 v22, v22
    v_exp_f32 v23, v23
    v_exp_f32 v24, v24
    v_exp_f32 v25, v25
    v_smfmac_f32_32x32x32_bf16 v[40:55], a[4:7], v[16:23], v6
    v_exp_f32 v26, v26
    v_exp_f32 v27, v27
    v_exp_f32 v28, v28
    v_mfma_f32_32x32x16_bf16 v[8:23], v[72:75], v[56:59], 0
    v_exp_f32 v29, v29
    v_exp_f32 v30, v30
    v_exp_f32 v31, v31
    v_exp_f32 v32, v32
    v_exp_f32 v33, v33
    v_exp_f32 v34, v34
    v_exp_f32 v35, v35
    v_smfmac_f32_32x32x32_bf16 v[40:55], a[8:11], v[24:31], v6
    v_exp_f32 v36, v36
    v_exp_f32 v37, v37
    v_exp_f32 v38, v38
    v_exp_f32 v39, v39
    v_exp_f32 v8, v8
    v_exp_f32 v9, v9
    v_smfmac_f32_32x32x32_bf16 v[40:55], a[12:15], v[32:39], v6
    v_exp_f32 v10, v10
    v_exp_f32 v11, v11
    v_exp_f32 v12, v12
    v_mfma_f32_32x32x16_bf16 v[24:39], v[76:79], v[56:59], 0
    v_exp_f32 v13, v13
    v_exp_f32 v14, v14
    v_exp_f32 v15, v15
    v_exp_f32 v16, v16
    v_exp_f32 v17, v17
    v_exp_f32 v18, v18
    v_exp_f32 v19, v19
    v_smfmac_f32_32x32x32_bf16 v[40:55], a[16:19], v[8:15], v6
    v_exp_f32 v20, v20
    v_exp_f32 v21, v21
    v_exp_f32 v22, v22
    v_exp_f32 v23, v23
    v_exp_f32 v24, v24
    v_exp_f32 v25, v25
    v_smfmac_f32_32x32x32_bf16 v[40:55], a[20:23], v[16:23], v6
    v_exp_f32 v26, v26
    v_exp_f32 v27, v27
    v_exp_f32 v28, v28
    v_mfma_f32_32x32x16_bf16 v[8:23], v[80:83], v[56:59], 0
    v_exp_f32 v29, v29
    v_exp_f32 v30, v30
    v_exp_f32 v31, v31
    v_exp_f32 v32, v32
    v_exp_f32 v33, v33
    v_exp_f32 v34, v34
    v_exp_f32 v35, v35
    v_smfmac_f32_32x32x32_bf16 v[40:55], a[24:27], v[24:31], v6
    v_exp_f32 v36, v36
    v_exp_f32 v37, v37
    v_exp_f32 v38, v38
    v_exp_f32 v39, v39
    v_exp_f32 v8, v8
    v_exp_f32 v9, v9
    v_smfmac_f32_32x32x32_bf16 v[40:55], a[28:31], v[32:39], v6
    v_exp_f32 v10, v10
    v_exp_f32 v11, v11
    v_exp_f32 v12, v12
    v_mfma_f32_32x32x16_bf16 v[24:39], v[84:87], v[56:59], 0
    v_exp_f32 v13, v13
    v_exp_f32 v14, v14
    v_exp_f32 v15, v15
    v_exp_f32 v16, v16
    v_exp_f32 v17, v17
    v_exp_f32 v18, v18
    v_exp_f32 v19, v19
    v_smfmac_f32_32x32x32_bf16 v[40:55], a[32:35], v[8:15], v6
    v_exp_f32 v20, v20
    v_exp_f32 v21, v21
    v_exp_f32 v22, v22
    v_exp_f32 v23, v23
    v_exp_f32 v24, v24
    v_exp_f32 v25, v25
    v_smfmac_f32_32x32x32_bf16 v[40:55], a[36:39], v[16:23], v6
    v_exp_f32 v26, v26
    v_exp_f32 v27, v27
    v_exp_f32 v28, v28
    v_mfma_f32_32x32x16_bf16 v[8:23], v[88:91], v[56:59], 0
    v_exp_f32 v29, v29
    v_exp_f32 v30, v30
    v_exp_f32 v31, v31
    v_exp_f32 v32, v32
    v_exp_f32 v33, v33
    v_exp_f32 v34, v34
    v_exp_f32 v35, v35
    v_smfmac_f32_32x32x32_bf16 v[40:55], a[40:43], v[24:31], v6
    v_exp_f32 v36, v36
    v_exp_f32 v37, v37
    v_exp_f32 v38, v38
    v_exp_f32 v39, v39
    v_exp_f32 v8, v8
    v_exp_f32 v9, v9
    v_smfmac_f32_32x32x32_bf16 v[40:55], a[44:47], v[32:39], v6
    v_exp_f32 v10, v10
    v_exp_f32 v11, v11
    v_exp_f32 v12, v12
    v_mfma_f32_32x32x16_bf16 v[24:39], v[92:95], v[56:59], 0
    v_exp_f32 v13, v13
    v_exp_f32 v14, v14
    v_exp_f32 v15, v15
    v_exp_f32 v16, v16
    v_exp_f32 v17, v17
    v_exp_f32 v18, v18
    v_exp_f32 v19, v19
    v_smfmac_f32_32x32x32_bf16 v[40:55], a[48:51], v[8:15], v6
    v_exp_f32 v20, v20
    v_exp_f32 v21, v21
    v_exp_f32 v22, v22
    v_exp_f32 v23, v23
    v_exp_f32 v24, v24
    v_exp_f32 v25, v25
    v_smfmac_f32_32x32x32_bf16 v[40:55], a[52:55], v[16:23], v6
    v_exp_f32 v26, v26
    v_exp_f32 v27, v27
    v_exp_f32 v28, v28
    v_mfma_f32_32x32x16_bf16 v[8:23], v[96:99], v[56:59], 0
    v_exp_f32 v29, v29
    v_exp_f32 v30, v30
    v_exp_f32 v31, v31
    v_exp_f32 v32, v32
    v_exp_f32 v33, v33
    v_exp_f32 v34, v34
    v_exp_f32 v35, v35
    v_smfmac_f32_32x32x32_bf16 v[40:55], a[56:59], v[24:31], v6
    v_exp_f32 v36, v36
    v_exp_f32 v37, v37
    v_exp_f32 v38, v38
    v_exp_f32 v39, v39
    v_exp_f32 v8, v8
    v_exp_f32 v9, v9
    v_smfmac_f32_32x32x32_bf16 v[40:55], a[60:63], v[32:39], v6
    v_exp_f32 v10, v10
    v_exp_f32 v11, v11
    v_exp_f32 v12, v12
    v_mfma_f32_32x32x16_bf16 v[24:39], v[100:103], v[56:59], 0
    v_exp_f32 v13, v13
    v_exp_f32 v14, v14
    v_exp_f32 v15, v15
    v_exp_f32 v16, v16
    v_exp_f32 v17, v17
    v_exp_f32 v18, v18
    v_exp_f32 v19, v19
    v_smfmac_f32_32x32x32_bf16 v[40:55], a[64:67], v[8:15], v6
    v_exp_f32 v20, v20
    v_exp_f32 v21, v21
    v_exp_f32 v22, v22
    v_exp_f32 v23, v23
    v_exp_f32 v24, v24
    v_exp_f32 v25, v25
    v_smfmac_f32_32x32x32_bf16 v[40:55], a[68:71], v[16:23], v6
    v_exp_f32 v26, v26
    v_exp_f32 v27, v27
    v_exp_f32 v28, v28
    v_mfma_f32_32x32x16_bf16 v[8:23], v[104:107], v[56:59], 0
    v_exp_f32 v29, v29
    v_exp_f32 v30, v30
    v_exp_f32 v31, v31
    v_exp_f32 v32, v32
    v_exp_f32 v33, v33
    v_exp_f32 v34, v34
    v_exp_f32 v35, v35
    v_smfmac_f32_32x32x32_bf16 v[40:55], a[72:75], v[24:31], v6
    v_exp_f32 v36, v36
    v_exp_f32 v37, v37
    v_exp_f32 v38, v38
    v_exp_f32 v39, v39
    v_exp_f32 v8, v8
    v_exp_f32 v9, v9
    v_smfmac_f32_32x32x32_bf16 v[40:55], a[76:79], v[32:39], v6
    v_exp_f32 v10, v10
    v_exp_f32 v11, v11
    v_exp_f32 v12, v12
    v_mfma_f32_32x32x16_bf16 v[24:39], v[108:111], v[56:59], 0
    v_exp_f32 v13, v13
    v_exp_f32 v14, v14
    v_exp_f32 v15, v15
    v_exp_f32 v16, v16
    v_exp_f32 v17, v17
    v_exp_f32 v18, v18
    v_exp_f32 v19, v19
    v_smfmac_f32_32x32x32_bf16 v[40:55], a[80:83], v[8:15], v6
    v_exp_f32 v20, v20
    v_exp_f32 v21, v21
    v_exp_f32 v22, v22
    v_exp_f32 v23, v23
    v_exp_f32 v24, v24
    v_exp_f32 v25, v25
    v_smfmac_f32_32x32x32_bf16 v[40:55], a[84:87], v[16:23], v6
    v_exp_f32 v26, v26
    v_exp_f32 v27, v27
    v_exp_f32 v28, v28
    v_mfma_f32_32x32x16_bf16 v[8:23], v[112:115], v[56:59], 0
    v_exp_f32 v29, v29
    v_exp_f32 v30, v30
    v_exp_f32 v31, v31
    v_exp_f32 v32, v32
    v_exp_f32 v33, v33
    v_exp_f32 v34, v34
    v_exp_f32 v35, v35
    v_smfmac_f32_32x32x32_bf16 v[40:55], a[88:91], v[24:31], v6
    v_exp_f32 v36, v36
    v_exp_f32 v37, v37
    v_exp_f32 v38, v38
    v_exp_f32 v39, v39
    v_exp_f32 v8, v8
    v_exp_f32 v9, v9
    v_smfmac_f32_32x32x32_bf16 v[40:55], a[92:95], v[32:39], v6
    v_exp_f32 v10, v10
    v_exp_f32 v11, v11
    v_exp_f32 v12, v12
    v_mfma_f32_32x32x16_bf16 v[24:39], v[116:119], v[56:59], 0
    v_exp_f32 v13, v13
    v_exp_f32 v14, v14
    v_exp_f32 v15, v15
    v_exp_f32 v16, v16
    v_exp_f32 v17, v17
    v_exp_f32 v18, v18
    v_exp_f32 v19, v19
    v_smfmac_f32_32x32x32_bf16 v[40:55], a[96:99], v[8:15], v6
    v_exp_f32 v20, v20
    v_exp_f32 v21, v21
    v_exp_f32 v22, v22
    v_exp_f32 v23, v23
    v_exp_f32 v24, v24
    v_exp_f32 v25, v25
    v_smfmac_f32_32x32x32_bf16 v[40:55], a[100:103], v[16:23], v6
    v_exp_f32 v26, v26
    v_exp_f32 v27, v27
    v_exp_f32 v28, v28
    v_mfma_f32_32x32x16_bf16 v[8:23], v[120:123], v[56:59], 0
    v_exp_f32 v29, v29
    v_exp_f32 v30, v30
    v_exp_f32 v31, v31
    v_exp_f32 v32, v32
    v_exp_f32 v33, v33
    v_exp_f32 v34, v34
    v_exp_f32 v35, v35
    v_smfmac_f32_32x32x32_bf16 v[40:55], a[104:107], v[24:31], v6
    v_exp_f32 v36, v36
    v_exp_f32 v37, v37
    v_exp_f32 v38, v38
    v_exp_f32 v39, v39
    v_exp_f32 v8, v8
    v_exp_f32 v9, v9
    v_smfmac_f32_32x32x32_bf16 v[40:55], a[108:111], v[32:39], v6
    v_exp_f32 v10, v10
    v_exp_f32 v11, v11
    v_exp_f32 v12, v12
    v_mfma_f32_32x32x16_bf16 v[24:39], v[124:127], v[56:59], 0
    ds_read_b128 v[56:59], v3 offset:6144
    ds_read_b32 v63, v62 offset:11264
    v_exp_f32 v13, v13
    v_exp_f32 v14, v14
    v_exp_f32 v15, v15
    v_exp_f32 v16, v16
    v_exp_f32 v17, v17
    v_exp_f32 v18, v18
    v_exp_f32 v19, v19
    v_smfmac_f32_32x32x32_bf16 v[40:55], a[112:115], v[8:15], v6
    v_exp_f32 v20, v20
    v_exp_f32 v21, v21
    v_exp_f32 v22, v22
    v_exp_f32 v23, v23
    v_exp_f32 v24, v24
    v_exp_f32 v25, v25
    v_smfmac_f32_32x32x32_bf16 v[40:55], a[116:119], v[16:23], v6
    s_waitcnt lgkmcnt(0)
    v_exp_f32 v26, v26
    v_exp_f32 v27, v27
    v_exp_f32 v28, v28
    v_mfma_f32_32x32x16_bf16 v[8:23], v[64:67], v[56:59], 0
    v_cmp_neq_f32 vcc, -1.0, v63
    v_exp_f32 v29, v29
    v_exp_f32 v30, v30
    v_exp_f32 v31, v31
    v_exp_f32 v32, v32
    v_exp_f32 v33, v33
    v_exp_f32 v34, v34
    v_exp_f32 v35, v35
    v_smfmac_f32_32x32x32_bf16 v[40:55], a[120:123], v[24:31], v6
    v_exp_f32 v36, v36
    v_exp_f32 v37, v37
    v_exp_f32 v38, v38
    v_exp_f32 v39, v39
    v_exp_f32 v8, v8
    v_exp_f32 v9, v9
    v_smfmac_f32_32x32x32_bf16 v[40:55], a[124:127], v[32:39], v6
    s_cbranch_vccnz L_aw5
L_ag5:
    v_exp_f32 v10, v10
    v_exp_f32 v11, v11
    v_exp_f32 v12, v12
    v_exp_f32 v13, v13
    v_mfma_f32_32x32x16_bf16 v[24:39], v[68:71], v[56:59], 0
    ds_write_addtid_b32 v40 offset:9216
    ds_write_addtid_b32 v41 offset:9472
    ds_write_addtid_b32 v42 offset:9728
    ds_write_addtid_b32 v43 offset:9984
    ds_write_addtid_b32 v44 offset:10240
    ds_write_addtid_b32 v45 offset:10496
    ds_write_addtid_b32 v46 offset:10752
    ds_write_addtid_b32 v47 offset:11008
    ds_write_addtid_b32 v48 offset:11264
    v_mfma_f32_32x32x8_bf16 v[40:55], v[60:61], v[60:61], 0
    v_exp_f32 v14, v14
    v_exp_f32 v15, v15
    v_exp_f32 v16, v16
    v_exp_f32 v17, v17
    v_exp_f32 v18, v18
    v_exp_f32 v19, v19
    v_smfmac_f32_32x32x32_bf16 v[40:55], a[0:3], v[8:15], v6
    v_exp_f32 v20, v20
    v_exp_f32 v21, v21
    v_exp_f32 v22, v22
    v_exp_f32 v23, v23
    v_exp_f32 v24, v24
    v_exp_f32 v25, v25
    v_smfmac_f32_32x32x32_bf16 v[40:55], a[4:7], v[16:23], v6
    v_exp_f32 v26, v26
    v_exp_f32 v27, v27
    v_exp_f32 v28, v28
    v_mfma_f32_32x32x16_bf16 v[8:23], v[72:75], v[56:59], 0
    v_exp_f32 v29, v29
    v_exp_f32 v30, v30
    v_exp_f32 v31, v31
    v_exp_f32 v32, v32
    v_exp_f32 v33, v33
    v_exp_f32 v34, v34
    v_exp_f32 v35, v35
    v_smfmac_f32_32x32x32_bf16 v[40:55], a[8:11], v[24:31], v6
    v_exp_f32 v36, v36
    v_exp_f32 v37, v37
    v_exp_f32 v38, v38
    v_exp_f32 v39, v39
    v_exp_f32 v8, v8
    v_exp_f32 v9, v9
    v_smfmac_f32_32x32x32_bf16 v[40:55], a[12:15], v[32:39], v6
    v_exp_f32 v10, v10
    v_exp_f32 v11, v11
    v_exp_f32 v12, v12
    v_mfma_f32_32x32x16_bf16 v[24:39], v[76:79], v[56:59], 0
    v_exp_f32 v13, v13
    v_exp_f32 v14, v14
    v_exp_f32 v15, v15
    v_exp_f32 v16, v16
    v_exp_f32 v17, v17
    v_exp_f32 v18, v18
    v_exp_f32 v19, v19
    v_smfmac_f32_32x32x32_bf16 v[40:55], a[16:19], v[8:15], v6
    v_exp_f32 v20, v20
    v_exp_f32 v21, v21
    v_exp_f32 v22, v22
    v_exp_f32 v23, v23
    v_exp_f32 v24, v24
    v_exp_f32 v25, v25
    v_smfmac_f32_32x32x32_bf16 v[40:55], a[20:23], v[16:23], v6
    v_exp_f32 v26, v26
    v_exp_f32 v27, v27
    v_exp_f32 v28, v28
    v_mfma_f32_32x32x16_bf16 v[8:23], v[80:83], v[56:59], 0
    v_exp_f32 v29, v29
    v_exp_f32 v30, v30
    v_exp_f32 v31, v31
    v_exp_f32 v32, v32
    v_exp_f32 v33, v33
    v_exp_f32 v34, v34
    v_exp_f32 v35, v35
    v_smfmac_f32_32x32x32_bf16 v[40:55], a[24:27], v[24:31], v6
    v_exp_f32 v36, v36
    v_exp_f32 v37, v37
    v_exp_f32 v38, v38
    v_exp_f32 v39, v39
    v_exp_f32 v8, v8
    v_exp_f32 v9, v9
    v_smfmac_f32_32x32x32_bf16 v[40:55], a[28:31], v[32:39], v6
    v_exp_f32 v10, v10
    v_exp_f32 v11, v11
    v_exp_f32 v12, v12
    v_mfma_f32_32x32x16_bf16 v[24:39], v[84:87], v[56:59], 0
    v_exp_f32 v13, v13
    v_exp_f32 v14, v14
    v_exp_f32 v15, v15
    v_exp_f32 v16, v16
    v_exp_f32 v17, v17
    v_exp_f32 v18, v18
    v_exp_f32 v19, v19
    v_smfmac_f32_32x32x32_bf16 v[40:55], a[32:35], v[8:15], v6
    v_exp_f32 v20, v20
    v_exp_f32 v21, v21
    v_exp_f32 v22, v22
    v_exp_f32 v23, v23
    v_exp_f32 v24, v24
    v_exp_f32 v25, v25
    v_smfmac_f32_32x32x32_bf16 v[40:55], a[36:39], v[16:23], v6
    v_exp_f32 v26, v26
    v_exp_f32 v27, v27
    v_exp_f32 v28, v28
    v_mfma_f32_32x32x16_bf16 v[8:23], v[88:91], v[56:59], 0
    v_exp_f32 v29, v29
    v_exp_f32 v30, v30
    v_exp_f32 v31, v31
    v_exp_f32 v32, v32
    v_exp_f32 v33, v33
    v_exp_f32 v34, v34
    v_exp_f32 v35, v35
    v_smfmac_f32_32x32x32_bf16 v[40:55], a[40:43], v[24:31], v6
    v_exp_f32 v36, v36
    v_exp_f32 v37, v37
    v_exp_f32 v38, v38
    v_exp_f32 v39, v39
    v_exp_f32 v8, v8
    v_exp_f32 v9, v9
    v_smfmac_f32_32x32x32_bf16 v[40:55], a[44:47], v[32:39], v6
    v_exp_f32 v10, v10
    v_exp_f32 v11, v11
    v_exp_f32 v12, v12
    v_mfma_f32_32x32x16_bf16 v[24:39], v[92:95], v[56:59], 0
    v_exp_f32 v13, v13
    v_exp_f32 v14, v14
    v_exp_f32 v15, v15
    v_exp_f32 v16, v16
    v_exp_f32 v17, v17
    v_exp_f32 v18, v18
    v_exp_f32 v19, v19
    v_smfmac_f32_32x32x32_bf16 v[40:55], a[48:51], v[8:15], v6
    v_exp_f32 v20, v20
    v_exp_f32 v21, v21
    v_exp_f32 v22, v22
    v_exp_f32 v23, v23
    v_exp_f32 v24, v24
    v_exp_f32 v25, v25
    v_smfmac_f32_32x32x32_bf16 v[40:55], a[52:55], v[16:23], v6
    v_exp_f32 v26, v26
    v_exp_f32 v27, v27
    v_exp_f32 v28, v28
    v_mfma_f32_32x32x16_bf16 v[8:23], v[96:99], v[56:59], 0
    v_exp_f32 v29, v29
    v_exp_f32 v30, v30
    v_exp_f32 v31, v31
    v_exp_f32 v32, v32
    v_exp_f32 v33, v33
    v_exp_f32 v34, v34
    v_exp_f32 v35, v35
    v_smfmac_f32_32x32x32_bf16 v[40:55], a[56:59], v[24:31], v6
    v_exp_f32 v36, v36
    v_exp_f32 v37, v37
    v_exp_f32 v38, v38
    v_exp_f32 v39, v39
    v_exp_f32 v8, v8
    v_exp_f32 v9, v9
    v_smfmac_f32_32x32x32_bf16 v[40:55], a[60:63], v[32:39], v6
    v_exp_f32 v10, v10
    v_exp_f32 v11, v11
    v_exp_f32 v12, v12
    v_mfma_f32_32x32x16_bf16 v[24:39], v[100:103], v[56:59], 0
    v_exp_f32 v13, v13
    v_exp_f32 v14, v14
    v_exp_f32 v15, v15
    v_exp_f32 v16, v16
    v_exp_f32 v17, v17
    v_exp_f32 v18, v18
    v_exp_f32 v19, v19
    v_smfmac_f32_32x32x32_bf16 v[40:55], a[64:67], v[8:15], v6
    v_exp_f32 v20, v20
    v_exp_f32 v21, v21
    v_exp_f32 v22, v22
    v_exp_f32 v23, v23
    v_exp_f32 v24, v24
    v_exp_f32 v25, v25
    v_smfmac_f32_32x32x32_bf16 v[40:55], a[68:71], v[16:23], v6
    v_exp_f32 v26, v26
    v_exp_f32 v27, v27
    v_exp_f32 v28, v28
    v_mfma_f32_32x32x16_bf16 v[8:23], v[104:107], v[56:59], 0
    v_exp_f32 v29, v29
    v_exp_f32 v30, v30
    v_exp_f32 v31, v31
    v_exp_f32 v32, v32
    v_exp_f32 v33, v33
    v_exp_f32 v34, v34
    v_exp_f32 v35, v35
    v_smfmac_f32_32x32x32_bf16 v[40:55], a[72:75], v[24:31], v6
    v_exp_f32 v36, v36
    v_exp_f32 v37, v37
    v_exp_f32 v38, v38
    v_exp_f32 v39, v39
    v_exp_f32 v8, v8
    v_exp_f32 v9, v9
    v_smfmac_f32_32x32x32_bf16 v[40:55], a[76:79], v[32:39], v6
    v_exp_f32 v10, v10
    v_exp_f32 v11, v11
    v_exp_f32 v12, v12
    v_mfma_f32_32x32x16_bf16 v[24:39], v[108:111], v[56:59], 0
    v_exp_f32 v13, v13
    v_exp_f32 v14, v14
    v_exp_f32 v15, v15
    v_exp_f32 v16, v16
    v_exp_f32 v17, v17
    v_exp_f32 v18, v18
    v_exp_f32 v19, v19
    v_smfmac_f32_32x32x32_bf16 v[40:55], a[80:83], v[8:15], v6
    v_exp_f32 v20, v20
    v_exp_f32 v21, v21
    v_exp_f32 v22, v22
    v_exp_f32 v23, v23
    v_exp_f32 v24, v24
    v_exp_f32 v25, v25
    v_smfmac_f32_32x32x32_bf16 v[40:55], a[84:87], v[16:23], v6
    v_exp_f32 v26, v26
    v_exp_f32 v27, v27
    v_exp_f32 v28, v28
    v_mfma_f32_32x32x16_bf16 v[8:23], v[112:115], v[56:59], 0
    v_exp_f32 v29, v29
    v_exp_f32 v30, v30
    v_exp_f32 v31, v31
    v_exp_f32 v32, v32
    v_exp_f32 v33, v33
    v_exp_f32 v34, v34
    v_exp_f32 v35, v35
    v_smfmac_f32_32x32x32_bf16 v[40:55], a[88:91], v[24:31], v6
    v_exp_f32 v36, v36
    v_exp_f32 v37, v37
    v_exp_f32 v38, v38
    v_exp_f32 v39, v39
    v_exp_f32 v8, v8
    v_exp_f32 v9, v9
    v_smfmac_f32_32x32x32_bf16 v[40:55], a[92:95], v[32:39], v6
    v_exp_f32 v10, v10
    v_exp_f32 v11, v11
    v_exp_f32 v12, v12
    v_mfma_f32_32x32x16_bf16 v[24:39], v[116:119], v[56:59], 0
    v_exp_f32 v13, v13
    v_exp_f32 v14, v14
    v_exp_f32 v15, v15
    v_exp_f32 v16, v16
    v_exp_f32 v17, v17
    v_exp_f32 v18, v18
    v_exp_f32 v19, v19
    v_smfmac_f32_32x32x32_bf16 v[40:55], a[96:99], v[8:15], v6
    v_exp_f32 v20, v20
    v_exp_f32 v21, v21
    v_exp_f32 v22, v22
    v_exp_f32 v23, v23
    v_exp_f32 v24, v24
    v_exp_f32 v25, v25
    v_smfmac_f32_32x32x32_bf16 v[40:55], a[100:103], v[16:23], v6
    v_exp_f32 v26, v26
    v_exp_f32 v27, v27
    v_exp_f32 v28, v28
    v_mfma_f32_32x32x16_bf16 v[8:23], v[120:123], v[56:59], 0
    v_exp_f32 v29, v29
    v_exp_f32 v30, v30
    v_exp_f32 v31, v31
    v_exp_f32 v32, v32
    v_exp_f32 v33, v33
    v_exp_f32 v34, v34
    v_exp_f32 v35, v35
    v_smfmac_f32_32x32x32_bf16 v[40:55], a[104:107], v[24:31], v6
    v_exp_f32 v36, v36
    v_exp_f32 v37, v37
    v_exp_f32 v38, v38
    v_exp_f32 v39, v39
    v_exp_f32 v8, v8
    v_exp_f32 v9, v9
    v_smfmac_f32_32x32x32_bf16 v[40:55], a[108:111], v[32:39], v6
    v_exp_f32 v10, v10
    v_exp_f32 v11, v11
    v_exp_f32 v12, v12
    v_mfma_f32_32x32x16_bf16 v[24:39], v[124:127], v[56:59], 0
    ds_read_b128 v[56:59], v3 offset:7168
    ds_read_b32 v63, v62 offset:2048
    v_exp_f32 v13, v13
    v_exp_f32 v14, v14
    v_exp_f32 v15, v15
    v_exp_f32 v16, v16
    v_exp_f32 v17, v17
    v_exp_f32 v18, v18
    v_exp_f32 v19, v19
    v_smfmac_f32_32x32x32_bf16 v[40:55], a[112:115], v[8:15], v6
    v_exp_f32 v20, v20
    v_exp_f32 v21, v21
    v_exp_f32 v22, v22
    v_exp_f32 v23, v23
    v_exp_f32 v24, v24
    v_exp_f32 v25, v25
    v_smfmac_f32_32x32x32_bf16 v[40:55], a[116:119], v[16:23], v6
    s_waitcnt lgkmcnt(0)
    v_exp_f32 v26, v26
    v_exp_f32 v27, v27
    v_exp_f32 v28, v28
    v_mfma_f32_32x32x16_bf16 v[8:23], v[64:67], v[56:59], 0
    v_cmp_neq_f32 vcc, -1.0, v63
    v_exp_f32 v29, v29
    v_exp_f32 v30, v30
    v_exp_f32 v31, v31
    v_exp_f32 v32, v32
    v_exp_f32 v33, v33
    v_exp_f32 v34, v34
    v_exp_f32 v35, v35
    v_smfmac_f32_32x32x32_bf16 v[40:55], a[120:123], v[24:31], v6
    v_exp_f32 v36, v36
    v_exp_f32 v37, v37
    v_exp_f32 v38, v38
    v_exp_f32 v39, v39
    v_exp_f32 v8, v8
    v_exp_f32 v9, v9
    v_smfmac_f32_32x32x32_bf16 v[40:55], a[124:127], v[32:39], v6
    s_cbranch_vccnz L_aw6
L_ag6:
    v_exp_f32 v10, v10
    v_exp_f32 v11, v11
    v_exp_f32 v12, v12
    v_exp_f32 v13, v13
    v_mfma_f32_32x32x16_bf16 v[24:39], v[68:71], v[56:59], 0
    ds_write_addtid_b32 v40 offset:0
    ds_write_addtid_b32 v41 offset:256
    ds_write_addtid_b32 v42 offset:512
    ds_write_addtid_b32 v43 offset:768
    ds_write_addtid_b32 v44 offset:1024
    ds_write_addtid_b32 v45 offset:1280
    ds_write_addtid_b32 v46 offset:1536
    ds_write_addtid_b32 v47 offset:1792
    ds_write_addtid_b32 v48 offset:2048
    v_mfma_f32_32x32x8_bf16 v[40:55], v[60:61], v[60:61], 0
    v_exp_f32 v14, v14
    v_exp_f32 v15, v15
    v_exp_f32 v16, v16
    v_exp_f32 v17, v17
    v_exp_f32 v18, v18
    v_exp_f32 v19, v19
    v_smfmac_f32_32x32x32_bf16 v[40:55], a[0:3], v[8:15], v6
    v_exp_f32 v20, v20
    v_exp_f32 v21, v21
    v_exp_f32 v22, v22
    v_exp_f32 v23, v23
    v_exp_f32 v24, v24
    v_exp_f32 v25, v25
    v_smfmac_f32_32x32x32_bf16 v[40:55], a[4:7], v[16:23], v6
    v_exp_f32 v26, v26
    v_exp_f32 v27, v27
    v_exp_f32 v28, v28
    v_mfma_f32_32x32x16_bf16 v[8:23], v[72:75], v[56:59], 0
    v_exp_f32 v29, v29
    v_exp_f32 v30, v30
    v_exp_f32 v31, v31
    v_exp_f32 v32, v32
    v_exp_f32 v33, v33
    v_exp_f32 v34, v34
    v_exp_f32 v35, v35
    v_smfmac_f32_32x32x32_bf16 v[40:55], a[8:11], v[24:31], v6
    v_exp_f32 v36, v36
    v_exp_f32 v37, v37
    v_exp_f32 v38, v38
    v_exp_f32 v39, v39
    v_exp_f32 v8, v8
    v_exp_f32 v9, v9
    v_smfmac_f32_32x32x32_bf16 v[40:55], a[12:15], v[32:39], v6
    v_exp_f32 v10, v10
    v_exp_f32 v11, v11
    v_exp_f32 v12, v12
    v_mfma_f32_32x32x16_bf16 v[24:39], v[76:79], v[56:59], 0
    v_exp_f32 v13, v13
    v_exp_f32 v14, v14
    v_exp_f32 v15, v15
    v_exp_f32 v16, v16
    v_exp_f32 v17, v17
    v_exp_f32 v18, v18
    v_exp_f32 v19, v19
    v_smfmac_f32_32x32x32_bf16 v[40:55], a[16:19], v[8:15], v6
    v_exp_f32 v20, v20
    v_exp_f32 v21, v21
    v_exp_f32 v22, v22
    v_exp_f32 v23, v23
    v_exp_f32 v24, v24
    v_exp_f32 v25, v25
    v_smfmac_f32_32x32x32_bf16 v[40:55], a[20:23], v[16:23], v6
    v_exp_f32 v26, v26
    v_exp_f32 v27, v27
    v_exp_f32 v28, v28
    v_mfma_f32_32x32x16_bf16 v[8:23], v[80:83], v[56:59], 0
    v_exp_f32 v29, v29
    v_exp_f32 v30, v30
    v_exp_f32 v31, v31
    v_exp_f32 v32, v32
    v_exp_f32 v33, v33
    v_exp_f32 v34, v34
    v_exp_f32 v35, v35
    v_smfmac_f32_32x32x32_bf16 v[40:55], a[24:27], v[24:31], v6
    v_exp_f32 v36, v36
    v_exp_f32 v37, v37
    v_exp_f32 v38, v38
    v_exp_f32 v39, v39
    v_exp_f32 v8, v8
    v_exp_f32 v9, v9
    v_smfmac_f32_32x32x32_bf16 v[40:55], a[28:31], v[32:39], v6
    v_exp_f32 v10, v10
    v_exp_f32 v11, v11
    v_exp_f32 v12, v12
    v_mfma_f32_32x32x16_bf16 v[24:39], v[84:87], v[56:59], 0
    v_exp_f32 v13, v13
    v_exp_f32 v14, v14
    v_exp_f32 v15, v15
    v_exp_f32 v16, v16
    v_exp_f32 v17, v17
    v_exp_f32 v18, v18
    v_exp_f32 v19, v19
    v_smfmac_f32_32x32x32_bf16 v[40:55], a[32:35], v[8:15], v6
    v_exp_f32 v20, v20
    v_exp_f32 v21, v21
    v_exp_f32 v22, v22
    v_exp_f32 v23, v23
    v_exp_f32 v24, v24
    v_exp_f32 v25, v25
    v_smfmac_f32_32x32x32_bf16 v[40:55], a[36:39], v[16:23], v6
    v_exp_f32 v26, v26
    v_exp_f32 v27, v27
    v_exp_f32 v28, v28
    v_mfma_f32_32x32x16_bf16 v[8:23], v[88:91], v[56:59], 0
    v_exp_f32 v29, v29
    v_exp_f32 v30, v30
    v_exp_f32 v31, v31
    v_exp_f32 v32, v32
    v_exp_f32 v33, v33
    v_exp_f32 v34, v34
    v_exp_f32 v35, v35
    v_smfmac_f32_32x32x32_bf16 v[40:55], a[40:43], v[24:31], v6
    v_exp_f32 v36, v36
    v_exp_f32 v37, v37
    v_exp_f32 v38, v38
    v_exp_f32 v39, v39
    v_exp_f32 v8, v8
    v_exp_f32 v9, v9
    v_smfmac_f32_32x32x32_bf16 v[40:55], a[44:47], v[32:39], v6
    v_exp_f32 v10, v10
    v_exp_f32 v11, v11
    v_exp_f32 v12, v12
    v_mfma_f32_32x32x16_bf16 v[24:39], v[92:95], v[56:59], 0
    v_exp_f32 v13, v13
    v_exp_f32 v14, v14
    v_exp_f32 v15, v15
    v_exp_f32 v16, v16
    v_exp_f32 v17, v17
    v_exp_f32 v18, v18
    v_exp_f32 v19, v19
    v_smfmac_f32_32x32x32_bf16 v[40:55], a[48:51], v[8:15], v6
    v_exp_f32 v20, v20
    v_exp_f32 v21, v21
    v_exp_f32 v22, v22
    v_exp_f32 v23, v23
    v_exp_f32 v24, v24
    v_exp_f32 v25, v25
    v_smfmac_f32_32x32x32_bf16 v[40:55], a[52:55], v[16:23], v6
    v_exp_f32 v26, v26
    v_exp_f32 v27, v27
    v_exp_f32 v28, v28
    v_mfma_f32_32x32x16_bf16 v[8:23], v[96:99], v[56:59], 0
    v_exp_f32 v29, v29
    v_exp_f32 v30, v30
    v_exp_f32 v31, v31
    v_exp_f32 v32, v32
    v_exp_f32 v33, v33
    v_exp_f32 v34, v34
    v_exp_f32 v35, v35
    v_smfmac_f32_32x32x32_bf16 v[40:55], a[56:59], v[24:31], v6
    v_exp_f32 v36, v36
    v_exp_f32 v37, v37
    v_exp_f32 v38, v38
    v_exp_f32 v39, v39
    v_exp_f32 v8, v8
    v_exp_f32 v9, v9
    v_smfmac_f32_32x32x32_bf16 v[40:55], a[60:63], v[32:39], v6
    v_exp_f32 v10, v10
    v_exp_f32 v11, v11
    v_exp_f32 v12, v12
    v_mfma_f32_32x32x16_bf16 v[24:39], v[100:103], v[56:59], 0
    v_exp_f32 v13, v13
    v_exp_f32 v14, v14
    v_exp_f32 v15, v15
    v_exp_f32 v16, v16
    v_exp_f32 v17, v17
    v_exp_f32 v18, v18
    v_exp_f32 v19, v19
    v_smfmac_f32_32x32x32_bf16 v[40:55], a[64:67], v[8:15], v6
    v_exp_f32 v20, v20
    v_exp_f32 v21, v21
    v_exp_f32 v22, v22
    v_exp_f32 v23, v23
    v_exp_f32 v24, v24
    v_exp_f32 v25, v25
    v_smfmac_f32_32x32x32_bf16 v[40:55], a[68:71], v[16:23], v6
    v_exp_f32 v26, v26
    v_exp_f32 v27, v27
    v_exp_f32 v28, v28
    v_mfma_f32_32x32x16_bf16 v[8:23], v[104:107], v[56:59], 0
    v_exp_f32 v29, v29
    v_exp_f32 v30, v30
    v_exp_f32 v31, v31
    v_exp_f32 v32, v32
    v_exp_f32 v33, v33
    v_exp_f32 v34, v34
    v_exp_f32 v35, v35
    v_smfmac_f32_32x32x32_bf16 v[40:55], a[72:75], v[24:31], v6
    v_exp_f32 v36, v36
    v_exp_f32 v37, v37
    v_exp_f32 v38, v38
    v_exp_f32 v39, v39
    v_exp_f32 v8, v8
    v_exp_f32 v9, v9
    v_smfmac_f32_32x32x32_bf16 v[40:55], a[76:79], v[32:39], v6
L_pg3:
    s_cbranch_execz L_wret
    v_exp_f32 v10, v10
    v_exp_f32 v11, v11
    v_exp_f32 v12, v12
    v_mfma_f32_32x32x16_bf16 v[24:39], v[108:111], v[56:59], 0
    v_exp_f32 v13, v13
    v_exp_f32 v14, v14
    v_exp_f32 v15, v15
    v_exp_f32 v16, v16
    v_exp_f32 v17, v17
    v_exp_f32 v18, v18
    v_exp_f32 v19, v19
    v_smfmac_f32_32x32x32_bf16 v[40:55], a[80:83], v[8:15], v6
    v_exp_f32 v20, v20
    v_exp_f32 v21, v21
    v_exp_f32 v22, v22
    v_exp_f32 v23, v23
    v_exp_f32 v24, v24
    v_exp_f32 v25, v25
    v_smfmac_f32_32x32x32_bf16 v[40:55], a[84:87], v[16:23], v6
    v_exp_f32 v26, v26
    v_exp_f32 v27, v27
    v_exp_f32 v28, v28
    v_mfma_f32_32x32x16_bf16 v[8:23], v[112:115], v[56:59], 0
    v_exp_f32 v29, v29
    v_exp_f32 v30, v30
    v_exp_f32 v31, v31
    v_exp_f32 v32, v32
    v_exp_f32 v33, v33
    v_exp_f32 v34, v34
    v_exp_f32 v35, v35
    v_smfmac_f32_32x32x32_bf16 v[40:55], a[88:91], v[24:31], v6
    v_exp_f32 v36, v36
    v_exp_f32 v37, v37
    v_exp_f32 v38, v38
    v_exp_f32 v39, v39
    v_exp_f32 v8, v8
    v_exp_f32 v9, v9
    v_smfmac_f32_32x32x32_bf16 v[40:55], a[92:95], v[32:39], v6
    v_exp_f32 v10, v10
    v_exp_f32 v11, v11
    v_exp_f32 v12, v12
    v_mfma_f32_32x32x16_bf16 v[24:39], v[116:119], v[56:59], 0
    v_exp_f32 v13, v13
    v_exp_f32 v14, v14
    v_exp_f32 v15, v15
    v_exp_f32 v16, v16
    v_exp_f32 v17, v17
    v_exp_f32 v18, v18
    v_exp_f32 v19, v19
    v_smfmac_f32_32x32x32_bf16 v[40:55], a[96:99], v[8:15], v6
    v_exp_f32 v20, v20
    v_exp_f32 v21, v21
    v_exp_f32 v22, v22
    v_exp_f32 v23, v23
    v_exp_f32 v24, v24
    v_exp_f32 v25, v25
    v_smfmac_f32_32x32x32_bf16 v[40:55], a[100:103], v[16:23], v6
    v_exp_f32 v26, v26
    v_exp_f32 v27, v27
    v_exp_f32 v28, v28
    v_mfma_f32_32x32x16_bf16 v[8:23], v[120:123], v[56:59], 0
    v_exp_f32 v29, v29
    v_exp_f32 v30, v30
    v_exp_f32 v31, v31
    v_exp_f32 v32, v32
    v_exp_f32 v33, v33
    v_exp_f32 v34, v34
    v_exp_f32 v35, v35
    v_smfmac_f32_32x32x32_bf16 v[40:55], a[104:107], v[24:31], v6
    v_exp_f32 v36, v36
    v_exp_f32 v37, v37
    v_exp_f32 v38, v38
    v_exp_f32 v39, v39
    v_exp_f32 v8, v8
    v_exp_f32 v9, v9
    v_smfmac_f32_32x32x32_bf16 v[40:55], a[108:111], v[32:39], v6
    v_exp_f32 v10, v10
    v_exp_f32 v11, v11
    v_exp_f32 v12, v12
    v_mfma_f32_32x32x16_bf16 v[24:39], v[124:127], v[56:59], 0
    ds_read_b32 v63, v62 offset:11264
    v_exp_f32 v13, v13
    v_exp_f32 v14, v14
    v_exp_f32 v15, v15
    v_exp_f32 v16, v16
    v_exp_f32 v17, v17
    v_exp_f32 v18, v18
    v_exp_f32 v19, v19
    v_smfmac_f32_32x32x32_bf16 v[40:55], a[112:115], v[8:15], v6
    v_exp_f32 v20, v20
    v_exp_f32 v21, v21
    v_exp_f32 v22, v22
    v_exp_f32 v23, v23
    v_exp_f32 v24, v24
    v_exp_f32 v25, v25
    v_smfmac_f32_32x32x32_bf16 v[40:55], a[116:119], v[16:23], v6
    s_waitcnt lgkmcnt(0)
    v_exp_f32 v26, v26
    v_exp_f32 v27, v27
    v_exp_f32 v28, v28
    v_cmp_neq_f32 vcc, -1.0, v63
    v_exp_f32 v29, v29
    v_exp_f32 v30, v30
    v_exp_f32 v31, v31
    v_exp_f32 v32, v32
    v_exp_f32 v33, v33
    v_exp_f32 v34, v34
    v_exp_f32 v35, v35
    v_smfmac_f32_32x32x32_bf16 v[40:55], a[120:123], v[24:31], v6
    v_exp_f32 v36, v36
    v_exp_f32 v37, v37
    v_exp_f32 v38, v38
    v_exp_f32 v39, v39
    v_lshrrev_b32 v14, 2, v1
    s_lshl_b32 s89, s54, 12
    v_smfmac_f32_32x32x32_bf16 v[40:55], a[124:127], v[32:39], v6
    s_cbranch_vccnz L_aw7
L_ag7:
    s_cmp_eq_u32 s52, 2
    s_cbranch_scc1 L_c3
    s_nop 8
    ds_write_addtid_b32 v40 offset:9216
    ds_write_addtid_b32 v41 offset:9472
    ds_write_addtid_b32 v42 offset:9728
    ds_write_addtid_b32 v43 offset:9984
    ds_write_addtid_b32 v44 offset:10240
    ds_write_addtid_b32 v45 offset:10496
    ds_write_addtid_b32 v46 offset:10752
    ds_write_addtid_b32 v47 offset:11008
    ds_write_addtid_b32 v48 offset:11264
    s_waitcnt lgkmcnt(0)
    s_barrier
    s_branch L_cend
L_c3:
    ds_read_b32 v11, v14 offset:26688
    v_and_b32 v15, 0x7c, v14
    s_add_u32 s89, s89, s76
    s_add_u32 s89, s89, 4230144
    s_add_u32 s88, s89, 4194304
    s_mov_b32 s80, 7
    s_mov_b32 s69, 562036736
    s_mov_b32 s70, 1602224128
    s_setprio 3
    v_mov_b32 v12, 0x207
    v_mov_b32 v13, v48
    s_nop 1
    v_permlane32_swap_b32 v48, v13
    s_barrier
    ds_read2st64_b32 v[8:9], v15 offset0:44 offset1:53
    ds_read_b32 v10, v15 offset:18176
    ds_read2st64_b32 v[16:17], v14 offset0:36 offset1:37
    ds_read2st64_b32 v[18:19], v14 offset0:38 offset1:39
    ds_read2st64_b32 v[20:21], v14 offset0:40 offset1:41
    ds_read2st64_b32 v[22:23], v14 offset0:42 offset1:43
    ds_read2st64_b32 v[24:25], v14 offset0:45 offset1:46
    ds_read2st64_b32 v[26:27], v14 offset0:47 offset1:48
    ds_read2st64_b32 v[28:29], v14 offset0:49 offset1:50
    ds_read2st64_b32 v[30:31], v14 offset0:51 offset1:52
    ds_read2st64_b32 v[32:33], v14 offset0:63 offset1:64
    ds_read2st64_b32 v[34:35], v14 offset0:65 offset1:66
    ds_read2st64_b32 v[36:37], v14 offset0:67 offset1:68
    ds_read2st64_b32 v[38:39], v14 offset0:69 offset1:70
    s_waitcnt lgkmcnt(12)
    v_add_f32 v8, v8, v9
    v_add_f32 v10, v10, v48
    v_add_f32 v8, v8, v10
    v_cmp_nge_f32 s[82:83], v8, s69
    v_cmp_nle_f32 s[90:91], v8, s70
    v_rcp_f32 v8, v8
    s_waitcnt lgkmcnt(8)
    v_add_f32 v40, v40, v16
    v_add_f32 v41, v41, v17
    v_add_f32 v42, v42, v18
    v_add_f32 v43, v43, v19
    v_add_f32 v44, v44, v20
    v_add_f32 v45, v45, v21
    v_add_f32 v46, v46, v22
    v_add_f32 v47, v47, v23
    v_mul_f32 v9, v8, v11
    s_or_b64 s[82:83], s[82:83], s[90:91]
    s_waitcnt lgkmcnt(4)
    v_add_f32 v40, v40, v24
    v_add_f32 v41, v41, v25
    v_add_f32 v42, v42, v26
    v_add_f32 v43, v43, v27
    v_add_f32 v44, v44, v28
    v_add_f32 v45, v45, v29
    v_add_f32 v46, v46, v30
    v_add_f32 v47, v47, v31
    s_waitcnt lgkmcnt(0)
    v_add_f32 v40, v40, v32
    v_add_f32 v41, v41, v33
    v_add_f32 v42, v42, v34
    v_add_f32 v43, v43, v35
    v_add_f32 v44, v44, v36
    v_add_f32 v45, v45, v37
    v_add_f32 v46, v46, v38
    v_add_f32 v47, v47, v39
    v_mul_f32 v40, v40, v9
    v_mul_f32 v41, v41, v9
    v_mul_f32 v42, v42, v9
    v_mul_f32 v43, v43, v9
    v_mul_f32 v44, v44, v9
    v_mul_f32 v45, v45, v9
    v_mul_f32 v46, v46, v9
    v_mul_f32 v47, v47, v9
    v_fma_f32 v10, v40, v41, v42
    v_cvt_pk_bf16_f32 v16, v40, v41
    v_fma_f32 v10, v43, v44, v10
    v_cvt_pk_bf16_f32 v17, v42, v43
    v_fma_f32 v10, v45, v46, v10
    v_cvt_pk_bf16_f32 v18, v44, v45
    v_add_f32 v10, v10, v47
    v_cvt_pk_bf16_f32 v19, v46, v47
    v_cmp_class_f32 vcc, v10, v12
    s_or_b64 vcc, vcc, s[82:83]
    s_cbranch_vccnz L_c3fb
    buffer_store_dwordx4 v[16:19], v1, s[24:27], s88 offen
    buffer_store_dwordx4 v[16:19], v1, s[24:27], s89 offen sc1
L_cend:
    s_barrier
    s_endpgm
L_c3fb:
    v_mov_b32 v25, v6
    v_mov_b32 v26, 0
    v_mov_b32 v27, 0
    v_mov_b32 v21, 1
    s_call_b64 s[92:93], L_fb
    buffer_store_dwordx4 v[84:87], v1, s[24:27], s89 offen sc1
    s_branch L_cend
L_aw2:
    ds_read_b32 v63, v62 offset:2048
    s_waitcnt lgkmcnt(0)
    v_cmp_neq_f32 vcc, -1.0, v63
    s_cbranch_vccz L_awd1
    s_sub_u32 s68, s68, 1
    s_cbranch_scc1 L_awd1_x
    s_sleep 1
    s_branch L_aw2
L_awd1_x:
    s_mov_b32 s68, 0
L_awd1:
    s_branch L_ag2
L_aw3:
    ds_read_b32 v63, v62 offset:11264
    s_waitcnt lgkmcnt(0)
    v_cmp_neq_f32 vcc, -1.0, v63
    s_cbranch_vccz L_awd2
    s_sub_u32 s68, s68, 1
    s_cbranch_scc1 L_awd2_x
    s_sleep 1
    s_branch L_aw3
L_awd2_x:
    s_mov_b32 s68, 0
L_awd2:
    s_branch L_ag3
L_aw4:
    ds_read_b32 v63, v62 offset:2048
    s_waitcnt lgkmcnt(0)
    v_cmp_neq_f32 vcc, -1.0, v63
    s_cbranch_vccz L_awd3
    s_sub_u32 s68, s68, 1
    s_cbranch_scc1 L_awd3_x
    s_sleep 1
    s_branch L_aw4
L_awd3_x:
    s_mov_b32 s68, 0
L_awd3:
    s_branch L_ag4
L_aw5:
    ds_read_b32 v63, v62 offset:11264
    s_waitcnt lgkmcnt(0)
    v_cmp_neq_f32 vcc, -1.0, v63
    s_cbranch_vccz L_awd4
    s_sub_u32 s68, s68, 1
    s_cbranch_scc1 L_awd4_x
    s_sleep 1
    s_branch L_aw5
L_awd4_x:
    s_mov_b32 s68, 0
L_awd4:
    s_branch L_ag5
L_aw6:
    ds_read_b32 v63, v62 offset:2048
    s_waitcnt lgkmcnt(0)
    v_cmp_neq_f32 vcc, -1.0, v63
    s_cbranch_vccz L_awd5
    s_sub_u32 s68, s68, 1
    s_cbranch_scc1 L_awd5_x
    s_sleep 1
    s_branch L_aw6
L_awd5_x:
    s_mov_b32 s68, 0
L_awd5:
    s_branch L_ag6
L_aw7:
    ds_read_b32 v63, v62 offset:11264
    s_waitcnt lgkmcnt(0)
    v_cmp_neq_f32 vcc, -1.0, v63
    s_cbranch_vccz L_awd6
    s_sub_u32 s68, s68, 1
    s_cbranch_scc1 L_awd6_x
    s_sleep 1
    s_branch L_aw7
L_awd6_x:
    s_mov_b32 s68, 0
L_awd6:
    s_branch L_ag7
L_rs3:
    s_cmp_eq_u32 s3, 0
    s_cbranch_scc1 L_ct3
    s_branch L_rs
L_rs6:
    s_cmp_eq_u32 s3, 0
    s_cbranch_scc1 L_ct6
    s_branch L_rs
L_rs10:
    s_cmp_eq_u32 s3, 0
    s_cbranch_scc1 L_ct10
    s_branch L_rs
L_rs16:
    s_cmp_eq_u32 s3, 0
    s_cbranch_scc1 L_ct16
    s_branch L_rs
L_rs:
    s_sub_u32 s3, s3, 1
    ds_read_b128 v[56:59], v3
L_pa7:
    buffer_load_dword v63, v0, s[24:27], 0 offen offset:1020 sc1
    s_waitcnt vmcnt(0)
    v_cmp_eq_u32 vcc, -1, v63
    s_cbranch_vccz L_pad8
    s_sub_u32 s68, s68, 1
    s_cbranch_scc1 L_pad8_x
    s_sleep 1
    s_branch L_pa7
L_pad8_x:
    s_mov_b32 s68, 0
L_pad8:
    s_nop 7
    s_branch L_kvr2
L_kvretry:
    s_sub_u32 s68, s68, 1
    s_cbranch_scc1 L_kvx

L_kvr2:
    v_mov_b32 v14, 0
    s_mov_b64 exec, 0x30003
    buffer_load_dword v14, v0, s[24:27], 0 offen offset:1020 sc1
    s_mov_b64 exec, -1
    global_load_dwordx4 v[64:67], v1, s[28:29] sc1
    global_load_dwordx4 a[0:3], v4, s[28:29] offset:1024 sc1
    global_load_dwordx4 a[4:7], v5, s[28:29] offset:1536 sc1
    global_load_dwordx4 v[68:71], v1, s[30:31] sc1
    global_load_dwordx4 a[8:11], v4, s[30:31] offset:1024 sc1
    global_load_dwordx4 a[12:15], v5, s[30:31] offset:1536 sc1
    s_mov_b64 exec, 0xc000c
    buffer_load_dword v2, v0, s[24:27], 0 offen offset:1020 sc1
    s_mov_b64 exec, -1
    global_load_dwordx4 v[72:75], v1, s[32:33] sc1
    global_load_dwordx4 a[16:19], v4, s[32:33] offset:1024 sc1
    global_load_dwordx4 a[20:23], v5, s[32:33] offset:1536 sc1
    global_load_dwordx4 v[76:79], v1, s[34:35] sc1
    global_load_dwordx4 a[24:27], v4, s[34:35] offset:1024 sc1
    global_load_dwordx4 a[28:31], v5, s[34:35] offset:1536 sc1
    s_branch L_kvok
L_kvx:
    s_mov_b32 s68, 0
    s_branch L_kvgo
L_p1r:
    s_sub_u32 s68, s68, 1
    s_cbranch_scc1 L_p1x
    s_mov_b64 exec, 0xc000c
    buffer_load_dword v2, v0, s[24:27], 0 offen offset:1020 sc1
    s_mov_b64 exec, -1
    global_load_dwordx4 v[72:75], v1, s[32:33] sc1
    global_load_dwordx4 a[16:19], v4, s[32:33] offset:1024 sc1
    global_load_dwordx4 a[20:23], v5, s[32:33] offset:1536 sc1
    global_load_dwordx4 v[76:79], v1, s[34:35] sc1
    global_load_dwordx4 a[24:27], v4, s[34:35] offset:1024 sc1
    global_load_dwordx4 a[28:31], v5, s[34:35] offset:1536 sc1
    global_load_dwordx4 v[80:83], v1, s[36:37] sc1
    global_load_dwordx4 a[32:35], v4, s[36:37] offset:1024 sc1
    global_load_dwordx4 a[36:39], v5, s[36:37] offset:1536 sc1
    s_branch L_p1w
L_p1x:
    s_mov_b32 s68, 0
    s_branch L_p1g
    .p2align 12
L_H:
    s_setprio 2
    s_and_b32 s78, s52, 3
    s_mov_b32 s74, 1.0
    s_mov_b32 s75, -1.0
    v_bfe_u32 v11, v2, 4, 1
    v_subrev_u32 v12, 32768, v4
    v_subrev_u32 v13, 98304, v5
    v_lshrrev_b32 v17, 1, v9
    v_xor_b32 v17, s58, v17
    v_lshlrev_b32 v32, 6, v17
    v_lshl_add_u32 v16, v8, 3, v9
    v_lshl_add_u32 v16, v16, 7, v32
    v_lshl_add_u32 v16, v11, 5, v16
    v_lshl_add_u32 v16, v10, 3, v16
    v_add_u32 v18, 32768, v16
    v_add_u32 v19, 98304, v16
    v_lshl_add_u32 v33, v8, 2, v9
    v_lshl_add_u32 v16, v33, 7, v32
    v_and_b32 v17, 1, v10
    v_lshl_add_u32 v16, v17, 5, v16
    v_lshl_add_u32 v16, v11, 4, v16
    v_lshrrev_b32 v17, 1, v10
    v_lshl_add_u32 v20, v17, 3, v16
    v_mov_b32 v21, 1
    v_mov_b32 v22, -1.0
    v_mov_b32 v25, 0xdddddddd
    v_mov_b32 v26, 0
    v_mov_b32 v27, 0
    s_mul_i32 s69, s57, 9216
    v_lshl_add_u32 v14, v2, 2, s69
    v_lshl_add_u32 v15, v6, 2, s69
    v_lshlrev_b32 v16, 5, v33
    v_lshl_add_u32 v16, v10, 3, v16
    s_lshl_b32 s69, s58, 10
    v_add_u32 v0, s69, v16
    v_and_b32 v16, 15, v2
    v_lshl_add_u32 v16, v8, 4, v16
    v_lshlrev_b32 v16, 4, v16
    s_lshl_b32 s69, s78, 10
    s_add_u32 s69, s69, 28992
    s_cmp_eq_u32 s78, 3
    s_cselect_b32 s69, 98304, s69
    v_add_u32 v23, s69, v16
    s_xor_b32 s70, s78, 1
    s_lshl_b32 s69, s70, 10
    s_add_u32 s69, s69, 28992
    s_cmp_eq_u32 s70, 3
    s_cselect_b32 s69, 98304, s69
    v_add_u32 v24, s69, v16
    s_mul_i32 s70, s78, 4608
    s_add_u32 s70, s70, 98304
    v_mul_u32_u24 v16, 72, v6
    v_lshl_add_u32 v17, v8, 3, v16
    v_add_u32 v3, s70, v17
    s_lshl_b32 s69, s57, 4
    v_xor_b32 v16, s69, v6
    v_mul_u32_u24 v16, 144, v16
    v_lshl_add_u32 v16, v8, 6, v16
    v_add_u32 v28, s70, v16
    v_lshrrev_b32 v16, 3, v2
    v_and_b32 v17, 7, v2
    v_mul_u32_u24 v34, 144, v16
    v_lshl_add_u32 v34, v17, 4, v34
    v_add_u32 v30, s70, v34
    v_lshlrev_b32 v16, 12, v16
    v_lshl_add_u32 v29, v17, 4, v16
    s_mul_i32 s70, s58, 9216
    s_mul_i32 s69, s57, 6912
    s_add_u32 s69, s69, s70
    s_add_u32 s69, s69, 98304
    v_mul_u32_u24 v16, 72, v33
    v_lshl_add_u32 v16, v11, 5, v16
    v_lshl_add_u32 v16, v10, 3, v16
    v_add_u32 v7, s69, v16
    s_lshl2_add_u32 s69, s58, s57
    s_lshl_b32 s69, s69, 10
    s_add_u32 s69, s69, 18432
    v_add_u32 v52, s69, v1
    v_lshl_add_u32 v16, v11, 1, v8
    v_lshl_add_u32 v16, v10, 3, v16
    v_bfe_u32 v17, v2, 2, 1
    v_lshl_add_u32 v16, v17, 2, v16
    v_lshlrev_b32 v9, 1, v16
    v_min_u32 v16, 16, v6
    v_lshlrev_b32 v16, 7, v16
    v_lshl_add_u32 v10, v8, 4, v16
    v_lshlrev_b32 v16, 12, v6
    v_lshl_add_u32 v6, v8, 7, v16
    v_and_b32 v16, 15, v2
    v_lshlrev_b32 v8, 8, v16
    s_lshl_b32 s69, s57, 2
    v_mov_b32 v2, s69
    v_mov_b32 v17, 0x3f803f80
    s_lshl3_add_u32 s79, s53, s73
    s_lshl2_add_u32 s79, s79, s78
    s_lshl_b32 s79, s79, 7
    s_add_u32 s79, s79, 262144
    s_lshl_b32 s88, s57, 15
    s_add_u32 s88, s88, s76
    s_add_u32 s88, s88, 4194304
    s_lshl_b32 s81, s54, 12
    s_add_u32 s81, s81, s88
    s_lshl2_add_u32 s84, s73, s78
    s_mul_i32 s85, s84, 69632
    s_add_u32 s85, s85, 1052672
    s_lshl1_add_u32 s86, s73, s58
    s_lshl_b32 s77, s73, 7
    s_add_u32 s55, s54, 2
    s_and_b32 s55, s55, 7
    s_lshl_b32 s55, s55, 7
    s_lshl_b32 s87, s53, 12
    s_lshl_b32 s69, s57, 7
    s_add_u32 s87, s87, s69
    s_add_u32 s87, s87, 262144
    ds_write_b64 v26, v[26:27] offset:26624
    ds_write_b64 v26, v[26:27] offset:26632
    v_mov_b32 v34, -1
    v_mov_b32 v35, -1
    ds_write_b64 v26, v[34:35] offset:26656
    ds_write_b64 v26, v[34:35] offset:26664
    ds_write_b64 v26, v[26:27] offset:26672
    ds_write_b64 v26, v[26:27] offset:26680
    ds_write_b32 v26, v17 offset:26640
    ds_write_b32 v26, v17 offset:26644
    ds_write_b32 v26, v17 offset:26648
    ds_write_b32 v26, v17 offset:26652
    s_waitcnt vmcnt(7)
    s_cmp_eq_u32 s89, 1
    s_cbranch_scc1 L_own
    s_waitcnt vmcnt(0)
L_own:
    s_barrier
    ds_read_b128 a[0:3], v48 offset:0
    ds_read_b128 a[4:7], v49 offset:0
    ds_read_b128 a[8:11], v50 offset:0
    ds_read_b128 a[12:15], v51 offset:0
    ds_read_b128 a[16:19], v48 offset:8192
    ds_read_b128 a[20:23], v49 offset:8192
    ds_read_b128 a[24:27], v50 offset:8192
    ds_read_b128 a[28:31], v51 offset:8192
    s_barrier
    ds_read_b128 a[32:35], v48 offset:16384
    ds_read_b128 a[36:39], v49 offset:16384
    ds_read_b128 a[40:43], v50 offset:16384
    ds_read_b128 a[44:47], v51 offset:16384
    ds_read_b128 a[48:51], v48 offset:24576
    ds_read_b128 a[52:55], v49 offset:24576
    ds_read_b128 a[56:59], v50 offset:24576
    ds_read_b128 a[60:63], v51 offset:24576
    s_cmp_eq_u32 s89, 1
    s_cbranch_scc0 L_nosig
    s_lshl_b32 s69, s72, 7
    s_mov_b64 exec, 1
    s_waitcnt vmcnt(0)
    buffer_atomic_add v21, v26, s[48:51], s69 offen sc1
    s_mov_b64 exec, -1
L_nosig:
    s_barrier
    ds_read_b128 a[64:67], v48 offset:32768
    ds_read_b128 a[68:71], v49 offset:32768
    ds_read_b128 a[72:75], v50 offset:32768
    ds_read_b128 a[76:79], v51 offset:32768
    ds_read_b128 a[80:83], v48 offset:40960
    ds_read_b128 a[84:87], v49 offset:40960
    ds_read_b128 a[88:91], v50 offset:40960
    ds_read_b128 a[92:95], v51 offset:40960
    s_barrier
    ds_read_b128 a[96:99], v48 offset:49152
    ds_read_b128 a[100:103], v49 offset:49152
    ds_read_b128 a[104:107], v50 offset:49152
    ds_read_b128 a[108:111], v51 offset:49152
    ds_read_b128 a[112:115], v48 offset:57344
    ds_read_b128 a[116:119], v49 offset:57344
    ds_read_b128 a[120:123], v50 offset:57344
    ds_read_b128 a[124:127], v51 offset:57344
    s_cmp_lt_u32 s72, 2
    s_cbranch_scc1 L_qaP
    s_barrier
    ds_read_b64_tr_b16 v[32:33], v19 offset:0
    ds_read_b64_tr_b16 v[34:35], v19 offset:512
    ds_read_b64_tr_b16 v[36:37], v19 offset:2048
    ds_read_b64_tr_b16 v[38:39], v19 offset:2560
    ds_read_b64_tr_b16 v[40:41], v19 offset:4096
    ds_read_b64_tr_b16 v[42:43], v19 offset:4608
    ds_read_b64_tr_b16 v[44:45], v19 offset:6144
    ds_read_b64_tr_b16 v[46:47], v19 offset:6656
    ds_read_b64_tr_b16 v[48:49], v19 offset:8192
    ds_read_b64_tr_b16 v[50:51], v19 offset:8704
    s_waitcnt lgkmcnt(8)
    v_mfma_f32_32x32x16_bf16 v[80:95], v[32:35], a[0:3], 0
    ds_read_b64_tr_b16 v[32:33], v19 offset:10240
    ds_read_b64_tr_b16 v[34:35], v19 offset:10752
    s_waitcnt lgkmcnt(8)
    v_mfma_f32_32x32x16_bf16 v[80:95], v[36:39], a[4:7], v[80:95]
    ds_read_b64_tr_b16 v[36:37], v19 offset:12288
    ds_read_b64_tr_b16 v[38:39], v19 offset:12800
    s_waitcnt lgkmcnt(8)
    v_mfma_f32_32x32x16_bf16 v[80:95], v[40:43], a[8:11], v[80:95]
    ds_read_b64_tr_b16 v[40:41], v19 offset:14336
    ds_read_b64_tr_b16 v[42:43], v19 offset:14848
    s_waitcnt lgkmcnt(8)
    v_mfma_f32_32x32x16_bf16 v[80:95], v[44:47], a[12:15], v[80:95]
    s_barrier
    ds_read_b64_tr_b16 v[44:45], v19 offset:16384
    ds_read_b64_tr_b16 v[46:47], v19 offset:16896
    s_waitcnt lgkmcnt(8)
    v_mfma_f32_32x32x16_bf16 v[80:95], v[48:51], a[16:19], v[80:95]
    ds_read_b64_tr_b16 v[48:49], v19 offset:18432
    ds_read_b64_tr_b16 v[50:51], v19 offset:18944
    s_waitcnt lgkmcnt(8)
    v_mfma_f32_32x32x16_bf16 v[80:95], v[32:35], a[20:23], v[80:95]
    ds_read_b64_tr_b16 v[32:33], v19 offset:20480
    ds_read_b64_tr_b16 v[34:35], v19 offset:20992
    s_waitcnt lgkmcnt(8)
    v_mfma_f32_32x32x16_bf16 v[80:95], v[36:39], a[24:27], v[80:95]
    ds_read_b64_tr_b16 v[36:37], v19 offset:22528
    ds_read_b64_tr_b16 v[38:39], v19 offset:23040
    s_waitcnt lgkmcnt(8)
    v_mfma_f32_32x32x16_bf16 v[80:95], v[40:43], a[28:31], v[80:95]
    ds_read_b64_tr_b16 v[40:41], v19 offset:24576
    ds_read_b64_tr_b16 v[42:43], v19 offset:25088
    s_waitcnt lgkmcnt(8)
    v_mfma_f32_32x32x16_bf16 v[80:95], v[44:47], a[32:35], v[80:95]
    ds_read_b64_tr_b16 v[44:45], v19 offset:26624
    ds_read_b64_tr_b16 v[46:47], v19 offset:27136
    s_waitcnt lgkmcnt(8)
    v_mfma_f32_32x32x16_bf16 v[80:95], v[48:51], a[36:39], v[80:95]
    ds_read_b64_tr_b16 v[48:49], v19 offset:28672
    ds_read_b64_tr_b16 v[50:51], v19 offset:29184
    s_waitcnt lgkmcnt(8)
    v_mfma_f32_32x32x16_bf16 v[80:95], v[32:35], a[40:43], v[80:95]
    ds_read_b64_tr_b16 v[32:33], v19 offset:30720
    ds_read_b64_tr_b16 v[34:35], v19 offset:31232
    s_waitcnt lgkmcnt(8)
    v_mfma_f32_32x32x16_bf16 v[80:95], v[36:39], a[44:47], v[80:95]
    s_barrier
    ds_read_b64_tr_b16 v[36:37], v19 offset:32768
    ds_read_b64_tr_b16 v[38:39], v19 offset:33280
    s_waitcnt lgkmcnt(8)
    v_mfma_f32_32x32x16_bf16 v[80:95], v[40:43], a[48:51], v[80:95]
    ds_read_b64_tr_b16 v[40:41], v19 offset:34816
    ds_read_b64_tr_b16 v[42:43], v19 offset:35328
    s_waitcnt lgkmcnt(8)
    v_mfma_f32_32x32x16_bf16 v[80:95], v[44:47], a[52:55], v[80:95]
    ds_read_b64_tr_b16 v[44:45], v19 offset:36864
    ds_read_b64_tr_b16 v[46:47], v19 offset:37376
    s_waitcnt lgkmcnt(8)
    v_mfma_f32_32x32x16_bf16 v[80:95], v[48:51], a[56:59], v[80:95]
    ds_read_b64_tr_b16 v[48:49], v19 offset:38912
    ds_read_b64_tr_b16 v[50:51], v19 offset:39424
    s_waitcnt lgkmcnt(8)
    v_mfma_f32_32x32x16_bf16 v[80:95], v[32:35], a[60:63], v[80:95]
    v_and_b32 v17, 0x80, v6
    s_cmp_eq_u32 s78, 3
    s_cbranch_scc0 L_cs9
    buffer_load_dword v16, v17, s[48:51], 0 offen sc1
L_cs9:
    ds_read_b64_tr_b16 v[32:33], v19 offset:40960
    ds_read_b64_tr_b16 v[34:35], v19 offset:41472
    s_waitcnt lgkmcnt(8)
    v_mfma_f32_32x32x16_bf16 v[80:95], v[36:39], a[64:67], v[80:95]
    ds_read_b64_tr_b16 v[36:37], v19 offset:43008
    ds_read_b64_tr_b16 v[38:39], v19 offset:43520
    s_waitcnt lgkmcnt(8)
    v_mfma_f32_32x32x16_bf16 v[80:95], v[40:43], a[68:71], v[80:95]
    ds_read_b64_tr_b16 v[40:41], v19 offset:45056
    ds_read_b64_tr_b16 v[42:43], v19 offset:45568
    s_waitcnt lgkmcnt(8)
    v_mfma_f32_32x32x16_bf16 v[80:95], v[44:47], a[72:75], v[80:95]
    ds_read_b64_tr_b16 v[44:45], v19 offset:47104
    ds_read_b64_tr_b16 v[46:47], v19 offset:47616
    s_waitcnt lgkmcnt(8)
    v_mfma_f32_32x32x16_bf16 v[80:95], v[48:51], a[76:79], v[80:95]
    s_barrier
    ds_read_b64_tr_b16 v[48:49], v19 offset:49152
    ds_read_b64_tr_b16 v[50:51], v19 offset:49664
    s_waitcnt lgkmcnt(8)
    v_mfma_f32_32x32x16_bf16 v[80:95], v[32:35], a[80:83], v[80:95]
    ds_read_b64_tr_b16 v[32:33], v19 offset:51200
    ds_read_b64_tr_b16 v[34:35], v19 offset:51712
    s_waitcnt lgkmcnt(8)
    v_mfma_f32_32x32x16_bf16 v[80:95], v[36:39], a[84:87], v[80:95]
    ds_read_b64_tr_b16 v[36:37], v19 offset:53248
    ds_read_b64_tr_b16 v[38:39], v19 offset:53760
    s_waitcnt lgkmcnt(8)
    v_mfma_f32_32x32x16_bf16 v[80:95], v[40:43], a[88:91], v[80:95]
    ds_read_b64_tr_b16 v[40:41], v19 offset:55296
    ds_read_b64_tr_b16 v[42:43], v19 offset:55808
    s_waitcnt lgkmcnt(8)
    v_mfma_f32_32x32x16_bf16 v[80:95], v[44:47], a[92:95], v[80:95]
    ds_read_b64_tr_b16 v[44:45], v19 offset:57344
    ds_read_b64_tr_b16 v[46:47], v19 offset:57856
    s_waitcnt lgkmcnt(8)
    v_mfma_f32_32x32x16_bf16 v[80:95], v[48:51], a[96:99], v[80:95]
    ds_read_b64_tr_b16 v[48:49], v19 offset:59392
    ds_read_b64_tr_b16 v[50:51], v19 offset:59904
    s_waitcnt lgkmcnt(8)
    v_mfma_f32_32x32x16_bf16 v[80:95], v[32:35], a[100:103], v[80:95]
    ds_read_b64_tr_b16 v[32:33], v19 offset:61440
    ds_read_b64_tr_b16 v[34:35], v19 offset:61952
    s_waitcnt lgkmcnt(8)
    v_mfma_f32_32x32x16_bf16 v[80:95], v[36:39], a[104:107], v[80:95]
    ds_read_b64_tr_b16 v[36:37], v19 offset:63488
    ds_read_b64_tr_b16 v[38:39], v19 offset:64000
    s_waitcnt lgkmcnt(8)
    v_mfma_f32_32x32x16_bf16 v[80:95], v[40:43], a[108:111], v[80:95]
    s_waitcnt lgkmcnt(6)
    v_mfma_f32_32x32x16_bf16 v[80:95], v[44:47], a[112:115], v[80:95]
    s_waitcnt lgkmcnt(4)
    v_mfma_f32_32x32x16_bf16 v[80:95], v[48:51], a[116:119], v[80:95]
    s_waitcnt lgkmcnt(2)
    v_mfma_f32_32x32x16_bf16 v[80:95], v[32:35], a[120:123], v[80:95]
    s_waitcnt lgkmcnt(0)
    v_mfma_f32_32x32x16_bf16 v[80:95], v[36:39], a[124:127], v[80:95]
    s_branch L_qad
L_qaP:
    s_barrier
    ds_read_b64_tr_b16 v[32:33], v19 offset:16384
    ds_read_b64_tr_b16 v[34:35], v19 offset:16896
    ds_read_b64_tr_b16 v[36:37], v19 offset:18432
    ds_read_b64_tr_b16 v[38:39], v19 offset:18944
    ds_read_b64_tr_b16 v[40:41], v19 offset:20480
    ds_read_b64_tr_b16 v[42:43], v19 offset:20992
    ds_read_b64_tr_b16 v[44:45], v19 offset:22528
    ds_read_b64_tr_b16 v[46:47], v19 offset:23040
    ds_read_b64_tr_b16 v[48:49], v19 offset:24576
    ds_read_b64_tr_b16 v[50:51], v19 offset:25088
    s_waitcnt lgkmcnt(8)
    v_mfma_f32_32x32x16_bf16 v[80:95], v[32:35], a[32:35], 0
    ds_read_b64_tr_b16 v[32:33], v19 offset:26624
    ds_read_b64_tr_b16 v[34:35], v19 offset:27136
    s_waitcnt lgkmcnt(8)
    v_mfma_f32_32x32x16_bf16 v[80:95], v[36:39], a[36:39], v[80:95]
    ds_read_b64_tr_b16 v[36:37], v19 offset:28672
    ds_read_b64_tr_b16 v[38:39], v19 offset:29184
    s_waitcnt lgkmcnt(8)
    v_mfma_f32_32x32x16_bf16 v[80:95], v[40:43], a[40:43], v[80:95]
    ds_read_b64_tr_b16 v[40:41], v19 offset:30720
    ds_read_b64_tr_b16 v[42:43], v19 offset:31232
    s_waitcnt lgkmcnt(8)
    v_mfma_f32_32x32x16_bf16 v[80:95], v[44:47], a[44:47], v[80:95]
    s_barrier
    ds_read_b64_tr_b16 v[44:45], v19 offset:32768
    ds_read_b64_tr_b16 v[46:47], v19 offset:33280
    s_waitcnt lgkmcnt(8)
    v_mfma_f32_32x32x16_bf16 v[80:95], v[48:51], a[48:51], v[80:95]
    ds_read_b64_tr_b16 v[48:49], v19 offset:34816
    ds_read_b64_tr_b16 v[50:51], v19 offset:35328
    s_waitcnt lgkmcnt(8)
    v_mfma_f32_32x32x16_bf16 v[80:95], v[32:35], a[52:55], v[80:95]
    ds_read_b64_tr_b16 v[32:33], v19 offset:36864
    ds_read_b64_tr_b16 v[34:35], v19 offset:37376
    s_waitcnt lgkmcnt(8)
    v_mfma_f32_32x32x16_bf16 v[80:95], v[36:39], a[56:59], v[80:95]
    ds_read_b64_tr_b16 v[36:37], v19 offset:38912
    ds_read_b64_tr_b16 v[38:39], v19 offset:39424
    s_waitcnt lgkmcnt(8)
    v_mfma_f32_32x32x16_bf16 v[80:95], v[40:43], a[60:63], v[80:95]
    ds_read_b64_tr_b16 v[40:41], v19 offset:40960
    ds_read_b64_tr_b16 v[42:43], v19 offset:41472
    s_waitcnt lgkmcnt(8)
    v_mfma_f32_32x32x16_bf16 v[80:95], v[44:47], a[64:67], v[80:95]
    ds_read_b64_tr_b16 v[44:45], v19 offset:43008
    ds_read_b64_tr_b16 v[46:47], v19 offset:43520
    s_waitcnt lgkmcnt(8)
    v_mfma_f32_32x32x16_bf16 v[80:95], v[48:51], a[68:71], v[80:95]
    ds_read_b64_tr_b16 v[48:49], v19 offset:45056
    ds_read_b64_tr_b16 v[50:51], v19 offset:45568
    s_waitcnt lgkmcnt(8)
    v_mfma_f32_32x32x16_bf16 v[80:95], v[32:35], a[72:75], v[80:95]
    ds_read_b64_tr_b16 v[32:33], v19 offset:47104
    ds_read_b64_tr_b16 v[34:35], v19 offset:47616
    s_waitcnt lgkmcnt(8)
    v_mfma_f32_32x32x16_bf16 v[80:95], v[36:39], a[76:79], v[80:95]
    s_barrier
    ds_read_b64_tr_b16 v[36:37], v19 offset:49152
    ds_read_b64_tr_b16 v[38:39], v19 offset:49664
    s_waitcnt lgkmcnt(8)
    v_mfma_f32_32x32x16_bf16 v[80:95], v[40:43], a[80:83], v[80:95]
    ds_read_b64_tr_b16 v[40:41], v19 offset:51200
    ds_read_b64_tr_b16 v[42:43], v19 offset:51712
    s_waitcnt lgkmcnt(8)
    v_mfma_f32_32x32x16_bf16 v[80:95], v[44:47], a[84:87], v[80:95]
    ds_read_b64_tr_b16 v[44:45], v19 offset:53248
    ds_read_b64_tr_b16 v[46:47], v19 offset:53760
    s_waitcnt lgkmcnt(8)
    v_mfma_f32_32x32x16_bf16 v[80:95], v[48:51], a[88:91], v[80:95]
    ds_read_b64_tr_b16 v[48:49], v19 offset:55296
    ds_read_b64_tr_b16 v[50:51], v19 offset:55808
    s_waitcnt lgkmcnt(8)
    v_mfma_f32_32x32x16_bf16 v[80:95], v[32:35], a[92:95], v[80:95]
    v_and_b32 v17, 0x80, v6
    s_cmp_eq_u32 s78, 3
    s_cbranch_scc0 L_cs10
    buffer_load_dword v16, v17, s[48:51], 0 offen sc1
L_cs10:
    ds_read_b64_tr_b16 v[32:33], v19 offset:57344
    ds_read_b64_tr_b16 v[34:35], v19 offset:57856
    s_waitcnt lgkmcnt(8)
    v_mfma_f32_32x32x16_bf16 v[80:95], v[36:39], a[96:99], v[80:95]
    ds_read_b64_tr_b16 v[36:37], v19 offset:59392
    ds_read_b64_tr_b16 v[38:39], v19 offset:59904
    s_waitcnt lgkmcnt(8)
    v_mfma_f32_32x32x16_bf16 v[80:95], v[40:43], a[100:103], v[80:95]
    ds_read_b64_tr_b16 v[40:41], v19 offset:61440
    ds_read_b64_tr_b16 v[42:43], v19 offset:61952
    s_waitcnt lgkmcnt(8)
    v_mfma_f32_32x32x16_bf16 v[80:95], v[44:47], a[104:107], v[80:95]
    ds_read_b64_tr_b16 v[44:45], v19 offset:63488
    ds_read_b64_tr_b16 v[46:47], v19 offset:64000
    s_waitcnt lgkmcnt(8)
    v_mfma_f32_32x32x16_bf16 v[80:95], v[48:51], a[108:111], v[80:95]
    s_barrier
    ds_read_b64_tr_b16 v[48:49], v19 offset:0
    ds_read_b64_tr_b16 v[50:51], v19 offset:512
    s_waitcnt lgkmcnt(8)
    v_mfma_f32_32x32x16_bf16 v[80:95], v[32:35], a[112:115], v[80:95]
    ds_read_b64_tr_b16 v[32:33], v19 offset:2048
    ds_read_b64_tr_b16 v[34:35], v19 offset:2560
    s_waitcnt lgkmcnt(8)
    v_mfma_f32_32x32x16_bf16 v[80:95], v[36:39], a[116:119], v[80:95]
    ds_read_b64_tr_b16 v[36:37], v19 offset:4096
    ds_read_b64_tr_b16 v[38:39], v19 offset:4608
    s_waitcnt lgkmcnt(8)
    v_mfma_f32_32x32x16_bf16 v[80:95], v[40:43], a[120:123], v[80:95]
    ds_read_b64_tr_b16 v[40:41], v19 offset:6144
    ds_read_b64_tr_b16 v[42:43], v19 offset:6656
    s_waitcnt lgkmcnt(8)
    v_mfma_f32_32x32x16_bf16 v[80:95], v[44:47], a[124:127], v[80:95]
    ds_read_b64_tr_b16 v[44:45], v19 offset:8192
    ds_read_b64_tr_b16 v[46:47], v19 offset:8704
    s_waitcnt lgkmcnt(8)
    v_mfma_f32_32x32x16_bf16 v[80:95], v[48:51], a[0:3], v[80:95]
    ds_read_b64_tr_b16 v[48:49], v19 offset:10240
    ds_read_b64_tr_b16 v[50:51], v19 offset:10752
    s_waitcnt lgkmcnt(8)
    v_mfma_f32_32x32x16_bf16 v[80:95], v[32:35], a[4:7], v[80:95]
    ds_read_b64_tr_b16 v[32:33], v19 offset:12288
    ds_read_b64_tr_b16 v[34:35], v19 offset:12800
    s_waitcnt lgkmcnt(8)
    v_mfma_f32_32x32x16_bf16 v[80:95], v[36:39], a[8:11], v[80:95]
    ds_read_b64_tr_b16 v[36:37], v19 offset:14336
    ds_read_b64_tr_b16 v[38:39], v19 offset:14848
    s_waitcnt lgkmcnt(8)
    v_mfma_f32_32x32x16_bf16 v[80:95], v[40:43], a[12:15], v[80:95]
    s_waitcnt lgkmcnt(6)
    v_mfma_f32_32x32x16_bf16 v[80:95], v[44:47], a[16:19], v[80:95]
    s_waitcnt lgkmcnt(4)
    v_mfma_f32_32x32x16_bf16 v[80:95], v[48:51], a[20:23], v[80:95]
    s_waitcnt lgkmcnt(2)
    v_mfma_f32_32x32x16_bf16 v[80:95], v[32:35], a[24:27], v[80:95]
    s_waitcnt lgkmcnt(0)
    v_mfma_f32_32x32x16_bf16 v[80:95], v[36:39], a[28:31], v[80:95]
L_qad:
    s_nop 11
    v_cvt_pk_bf16_f32 v104, v80, v81
    v_cvt_pk_bf16_f32 v105, v82, v83
    v_cvt_pk_bf16_f32 v106, v84, v85
    v_cvt_pk_bf16_f32 v107, v86, v87
    v_cvt_pk_bf16_f32 v108, v88, v89
    v_cvt_pk_bf16_f32 v109, v90, v91
    v_cvt_pk_bf16_f32 v110, v92, v93
    v_cvt_pk_bf16_f32 v111, v94, v95
    s_cmp_eq_u32 s78, 3
    s_cbranch_scc0 L_cld12
    s_branch L_cl11c
L_cl11:
    buffer_load_dword v16, v17, s[48:51], 0 offen sc1
L_cl11c:
    s_waitcnt vmcnt(0)
    v_cmp_gt_u32 vcc, 32, v16
    s_cbranch_vccz L_cld12
    s_sub_u32 s68, s68, 1
    s_cbranch_scc1 L_cld12_x
    s_sleep 2
    s_branch L_cl11
L_cld12_x:
    s_mov_b32 s68, 0
L_cld12:
    s_barrier
    ds_read_b64_tr_b16 v[32:33], v18 offset:0
    ds_read_b64_tr_b16 v[34:35], v18 offset:512
    ds_read_b64_tr_b16 v[36:37], v18 offset:2048
    ds_read_b64_tr_b16 v[38:39], v18 offset:2560
    ds_read_b64_tr_b16 v[40:41], v18 offset:4096
    ds_read_b64_tr_b16 v[42:43], v18 offset:4608
    ds_read_b64_tr_b16 v[44:45], v18 offset:6144
    ds_read_b64_tr_b16 v[46:47], v18 offset:6656
    ds_read_b64_tr_b16 v[48:49], v18 offset:8192
    ds_read_b64_tr_b16 v[50:51], v18 offset:8704
    s_waitcnt lgkmcnt(8)
    v_mfma_f32_32x32x16_bf16 v[64:79], v[32:35], a[0:3], 0
    ds_read_b64_tr_b16 v[32:33], v18 offset:10240
    ds_read_b64_tr_b16 v[34:35], v18 offset:10752
    s_waitcnt lgkmcnt(8)
    v_mfma_f32_32x32x16_bf16 v[64:79], v[36:39], a[4:7], v[64:79]
    ds_read_b64_tr_b16 v[36:37], v18 offset:12288
    ds_read_b64_tr_b16 v[38:39], v18 offset:12800
    s_waitcnt lgkmcnt(8)
    v_mfma_f32_32x32x16_bf16 v[64:79], v[40:43], a[8:11], v[64:79]
    ds_read_b64_tr_b16 v[40:41], v18 offset:14336
    ds_read_b64_tr_b16 v[42:43], v18 offset:14848
    s_waitcnt lgkmcnt(8)
    v_mfma_f32_32x32x16_bf16 v[64:79], v[44:47], a[12:15], v[64:79]
    ds_read_b64_tr_b16 v[44:45], v18 offset:16384
    ds_read_b64_tr_b16 v[46:47], v18 offset:16896
    s_waitcnt lgkmcnt(8)
    v_mfma_f32_32x32x16_bf16 v[64:79], v[48:51], a[16:19], v[64:79]
    ds_read_b64_tr_b16 v[48:49], v18 offset:18432
    ds_read_b64_tr_b16 v[50:51], v18 offset:18944
    s_waitcnt lgkmcnt(8)
    v_mfma_f32_32x32x16_bf16 v[64:79], v[32:35], a[20:23], v[64:79]
    ds_read_b64_tr_b16 v[32:33], v18 offset:20480
    ds_read_b64_tr_b16 v[34:35], v18 offset:20992
    s_waitcnt lgkmcnt(8)
    v_mfma_f32_32x32x16_bf16 v[64:79], v[36:39], a[24:27], v[64:79]
    ds_read_b64_tr_b16 v[36:37], v18 offset:22528
    ds_read_b64_tr_b16 v[38:39], v18 offset:23040
    s_waitcnt lgkmcnt(8)
    v_mfma_f32_32x32x16_bf16 v[64:79], v[40:43], a[28:31], v[64:79]
    ds_read_b64_tr_b16 v[40:41], v18 offset:24576
    ds_read_b64_tr_b16 v[42:43], v18 offset:25088
    s_waitcnt lgkmcnt(8)
    v_mfma_f32_32x32x16_bf16 v[64:79], v[44:47], a[32:35], v[64:79]
    ds_read_b64_tr_b16 v[44:45], v18 offset:26624
    ds_read_b64_tr_b16 v[46:47], v18 offset:27136
    s_waitcnt lgkmcnt(8)
    v_mfma_f32_32x32x16_bf16 v[64:79], v[48:51], a[36:39], v[64:79]
    ds_read_b64_tr_b16 v[48:49], v18 offset:28672
    ds_read_b64_tr_b16 v[50:51], v18 offset:29184
    s_waitcnt lgkmcnt(8)
    v_mfma_f32_32x32x16_bf16 v[64:79], v[32:35], a[40:43], v[64:79]
    ds_read_b64_tr_b16 v[32:33], v18 offset:30720
    ds_read_b64_tr_b16 v[34:35], v18 offset:31232
    s_waitcnt lgkmcnt(8)
    v_mfma_f32_32x32x16_bf16 v[64:79], v[36:39], a[44:47], v[64:79]
    s_waitcnt lgkmcnt(0)
    s_barrier
    ds_write_b128 v52, v[104:107] offset:0
    ds_write_b128 v52, v[108:111] offset:2048
    ds_write2st64_b32 v14, v22, v22 offset0:8 offset1:17
    ds_write2st64_b32 v14, v22, v22 offset0:26 offset1:35
    v_mfma_f32_32x32x16_bf16 v[64:79], v[40:43], a[48:51], v[64:79]
    v_mfma_f32_32x32x16_bf16 v[64:79], v[44:47], a[52:55], v[64:79]
    v_mfma_f32_32x32x16_bf16 v[64:79], v[48:51], a[56:59], v[64:79]
    v_mfma_f32_32x32x16_bf16 v[64:79], v[32:35], a[60:63], v[64:79]
    s_waitcnt lgkmcnt(0)
    s_barrier
    s_setprio 0
    ds_read_b64_tr_b16 v[32:33], v18 offset:32768
    ds_read_b64_tr_b16 v[34:35], v18 offset:33280
    s_waitcnt lgkmcnt(0)
    v_mfma_f32_32x32x16_bf16 v[64:79], v[32:35], a[64:67], v[64:79]
    ds_read_b64_tr_b16 v[36:37], v18 offset:34816
    ds_read_b64_tr_b16 v[38:39], v18 offset:35328
    s_waitcnt lgkmcnt(0)
    v_mfma_f32_32x32x16_bf16 v[64:79], v[36:39], a[68:71], v[64:79]
    ds_read_b64_tr_b16 v[40:41], v18 offset:36864
    ds_read_b64_tr_b16 v[42:43], v18 offset:37376
    s_waitcnt lgkmcnt(0)
    v_mfma_f32_32x32x16_bf16 v[64:79], v[40:43], a[72:75], v[64:79]
    ds_read_b64_tr_b16 v[44:45], v18 offset:38912
    ds_read_b64_tr_b16 v[46:47], v18 offset:39424
    s_waitcnt lgkmcnt(0)
    v_mfma_f32_32x32x16_bf16 v[64:79], v[44:47], a[76:79], v[64:79]
    ds_read_b64_tr_b16 v[48:49], v18 offset:40960
    ds_read_b64_tr_b16 v[50:51], v18 offset:41472
    s_waitcnt lgkmcnt(0)
    v_mfma_f32_32x32x16_bf16 v[64:79], v[48:51], a[80:83], v[64:79]
    ds_read_b64_tr_b16 v[32:33], v18 offset:43008
    ds_read_b64_tr_b16 v[34:35], v18 offset:43520
    s_waitcnt lgkmcnt(0)
    v_mfma_f32_32x32x16_bf16 v[64:79], v[32:35], a[84:87], v[64:79]
    ds_read_b64_tr_b16 v[36:37], v18 offset:45056
    ds_read_b64_tr_b16 v[38:39], v18 offset:45568
    s_waitcnt lgkmcnt(0)
    v_mfma_f32_32x32x16_bf16 v[64:79], v[36:39], a[88:91], v[64:79]
    ds_read_b64_tr_b16 v[40:41], v18 offset:47104
    ds_read_b64_tr_b16 v[42:43], v18 offset:47616
    s_waitcnt lgkmcnt(0)
    v_mfma_f32_32x32x16_bf16 v[64:79], v[40:43], a[92:95], v[64:79]
    ds_read_b64_tr_b16 v[44:45], v18 offset:49152
    ds_read_b64_tr_b16 v[46:47], v18 offset:49664
    s_waitcnt lgkmcnt(0)
    v_mfma_f32_32x32x16_bf16 v[64:79], v[44:47], a[96:99], v[64:79]
    ds_read_b64_tr_b16 v[48:49], v18 offset:51200
    ds_read_b64_tr_b16 v[50:51], v18 offset:51712
    s_waitcnt lgkmcnt(0)
    v_mfma_f32_32x32x16_bf16 v[64:79], v[48:51], a[100:103], v[64:79]
    ds_read_b64_tr_b16 v[32:33], v18 offset:53248
    ds_read_b64_tr_b16 v[34:35], v18 offset:53760
    s_waitcnt lgkmcnt(0)
    v_mfma_f32_32x32x16_bf16 v[64:79], v[32:35], a[104:107], v[64:79]
    ds_read_b64_tr_b16 v[36:37], v18 offset:55296
    ds_read_b64_tr_b16 v[38:39], v18 offset:55808
    s_waitcnt lgkmcnt(0)
    v_mfma_f32_32x32x16_bf16 v[64:79], v[36:39], a[108:111], v[64:79]
    ds_read_b64_tr_b16 v[40:41], v18 offset:57344
    ds_read_b64_tr_b16 v[42:43], v18 offset:57856
    s_waitcnt lgkmcnt(0)
    v_mfma_f32_32x32x16_bf16 v[64:79], v[40:43], a[112:115], v[64:79]
    ds_read_b64_tr_b16 v[44:45], v18 offset:59392
    ds_read_b64_tr_b16 v[46:47], v18 offset:59904
    s_waitcnt lgkmcnt(0)
    v_mfma_f32_32x32x16_bf16 v[64:79], v[44:47], a[116:119], v[64:79]
    ds_read_b64_tr_b16 v[48:49], v18 offset:61440
    ds_read_b64_tr_b16 v[50:51], v18 offset:61952
    s_waitcnt lgkmcnt(0)
    v_mfma_f32_32x32x16_bf16 v[64:79], v[48:51], a[120:123], v[64:79]
    ds_read_b64_tr_b16 v[32:33], v18 offset:63488
    ds_read_b64_tr_b16 v[34:35], v18 offset:64000
    s_waitcnt lgkmcnt(0)
    v_mfma_f32_32x32x16_bf16 v[64:79], v[32:35], a[124:127], v[64:79]
    s_setprio 2
    s_cmp_eq_u32 s56, 3
    s_cbranch_scc0 L_nogp
    s_cmp_eq_u32 s78, 0
    s_cbranch_scc0 L_nogp
    ds_read_b32 v16, v14 offset:26688
    s_lshl_b32 s70, s53, 8
    s_add_u32 s70, s70, 147456
    s_waitcnt lgkmcnt(0)
    buffer_store_dword v16, v14, s[24:27], s70 offen sc1
L_nogp:
    s_nop 0
    ds_read_b64_tr_b16 v[40:41], v0 offset:26944
    ds_read_b64_tr_b16 v[42:43], v0 offset:27200
    ds_read_b64_tr_b16 v[44:45], v0 offset:27456
    ds_read_b64_tr_b16 v[46:47], v0 offset:27712
L_pg4:
    s_cbranch_execz L_wret
    s_nop 4
    v_cvt_pk_bf16_f32 v56, v64, v65
    v_cvt_pk_bf16_f32 v57, v66, v67
    v_cvt_pk_bf16_f32 v58, v68, v69
    v_cvt_pk_bf16_f32 v59, v70, v71
    v_cvt_pk_bf16_f32 v60, v72, v73
    v_cvt_pk_bf16_f32 v61, v74, v75
    v_cvt_pk_bf16_f32 v62, v76, v77
    v_cvt_pk_bf16_f32 v63, v78, v79
    s_waitcnt lgkmcnt(0)
    s_setprio 0
    v_mfma_f32_32x32x16_bf16 v[96:111], v[40:43], v[56:59], 0
    v_mfma_f32_32x32x16_bf16 v[112:127], v[44:47], v[60:63], 0
    s_setprio 2
    s_nop 10
    v_exp_f32 v104, -v96
    v_exp_f32 v96, v96
    v_exp_f32 v105, -v97
    v_exp_f32 v97, v97
    v_exp_f32 v106, -v98
    v_exp_f32 v98, v98
    v_exp_f32 v107, -v99
    v_exp_f32 v99, v99
    v_exp_f32 v108, -v100
    v_exp_f32 v100, v100
    v_exp_f32 v109, -v101
    v_exp_f32 v101, v101
    v_exp_f32 v110, -v102
    v_exp_f32 v102, v102
    v_exp_f32 v111, -v103
    v_exp_f32 v103, v103
    v_exp_f32 v120, -v112
    v_exp_f32 v112, v112
    v_exp_f32 v121, -v113
    v_exp_f32 v113, v113
    v_exp_f32 v122, -v114
    v_exp_f32 v114, v114
    v_exp_f32 v123, -v115
    v_exp_f32 v115, v115
    v_exp_f32 v124, -v116
    v_exp_f32 v116, v116
    v_exp_f32 v125, -v117
    v_exp_f32 v117, v117
    v_exp_f32 v126, -v118
    v_exp_f32 v118, v118
    v_exp_f32 v127, -v119
    v_exp_f32 v119, v119
L_ksum:
    v_pk_add_f32 v[32:33], v[96:97], v[98:99]
    v_pk_add_f32 v[34:35], v[104:105], v[106:107]
    v_pk_add_f32 v[36:37], v[112:113], v[114:115]
    v_pk_add_f32 v[38:39], v[120:121], v[122:123]
    v_pk_add_f32 v[32:33], v[32:33], v[100:101]
    v_pk_add_f32 v[34:35], v[34:35], v[108:109]
    v_pk_add_f32 v[36:37], v[36:37], v[116:117]
    v_pk_add_f32 v[38:39], v[38:39], v[124:125]
    v_pk_add_f32 v[32:33], v[32:33], v[102:103]
    v_pk_add_f32 v[34:35], v[34:35], v[110:111]
    v_pk_add_f32 v[36:37], v[36:37], v[118:119]
    v_pk_add_f32 v[38:39], v[38:39], v[126:127]
    v_add_f32 v48, v32, v33
    v_add_f32 v49, v34, v35
    v_add_f32 v50, v36, v37
    v_add_f32 v51, v38, v39
    s_nop 1
    v_permlane32_swap_b32 v48, v49
    v_permlane32_swap_b32 v50, v51
    v_add_f32 v48, v48, v49
    v_add_f32 v50, v50, v51
    v_max_f32 v16, v48, v50
    v_cmp_lt_f32 vcc, 0x4e800000, v16
    s_cbranch_vccnz L_kredo
    v_rcp_f32 v48, v48
    v_rcp_f32 v50, v50
    s_nop 0
    v_mov_b32 v49, v48
    v_mov_b32 v51, v50
    s_nop 1
    v_permlane32_swap_b32 v48, v49
    v_permlane32_swap_b32 v50, v51
    v_pk_mul_f32 v[96:97], v[96:97], v[48:49] op_sel_hi:[1,0]
    v_pk_mul_f32 v[98:99], v[98:99], v[48:49] op_sel_hi:[1,0]
    v_pk_mul_f32 v[100:101], v[100:101], v[48:49] op_sel_hi:[1,0]
    v_pk_mul_f32 v[102:103], v[102:103], v[48:49] op_sel_hi:[1,0]
    v_pk_mul_f32 v[104:105], v[104:105], v[48:49] op_sel:[0,1] op_sel_hi:[1,1]
    v_pk_mul_f32 v[106:107], v[106:107], v[48:49] op_sel:[0,1] op_sel_hi:[1,1]
    v_pk_mul_f32 v[108:109], v[108:109], v[48:49] op_sel:[0,1] op_sel_hi:[1,1]
    v_pk_mul_f32 v[110:111], v[110:111], v[48:49] op_sel:[0,1] op_sel_hi:[1,1]
    v_cvt_pk_bf16_f32 v96, v96, v97
    v_cvt_pk_bf16_f32 v97, v98, v99
    v_cvt_pk_bf16_f32 v98, v100, v101
    v_cvt_pk_bf16_f32 v99, v102, v103
    v_cvt_pk_bf16_f32 v100, v104, v105
    v_cvt_pk_bf16_f32 v101, v106, v107
    v_cvt_pk_bf16_f32 v102, v108, v109
    v_cvt_pk_bf16_f32 v103, v110, v111
    v_pk_mul_f32 v[112:113], v[112:113], v[50:51] op_sel_hi:[1,0]
    v_pk_mul_f32 v[114:115], v[114:115], v[50:51] op_sel_hi:[1,0]
    v_pk_mul_f32 v[116:117], v[116:117], v[50:51] op_sel_hi:[1,0]
    v_pk_mul_f32 v[118:119], v[118:119], v[50:51] op_sel_hi:[1,0]
    v_pk_mul_f32 v[120:121], v[120:121], v[50:51] op_sel:[0,1] op_sel_hi:[1,1]
    v_pk_mul_f32 v[122:123], v[122:123], v[50:51] op_sel:[0,1] op_sel_hi:[1,1]
    v_pk_mul_f32 v[124:125], v[124:125], v[50:51] op_sel:[0,1] op_sel_hi:[1,1]
    v_pk_mul_f32 v[126:127], v[126:127], v[50:51] op_sel:[0,1] op_sel_hi:[1,1]
    v_cvt_pk_bf16_f32 v112, v112, v113
    v_cvt_pk_bf16_f32 v113, v114, v115
    v_cvt_pk_bf16_f32 v114, v116, v117
    v_cvt_pk_bf16_f32 v115, v118, v119
    v_cvt_pk_bf16_f32 v116, v120, v121
    v_cvt_pk_bf16_f32 v117, v122, v123
    v_cvt_pk_bf16_f32 v118, v124, v125
    v_cvt_pk_bf16_f32 v119, v126, v127
    ds_write_b64 v3, v[96:97] offset:0
    ds_write_b64 v3, v[98:99] offset:16
    ds_write_b64 v3, v[100:101] offset:32
    ds_write_b64 v3, v[102:103] offset:48
    ds_write_b64 v3, v[112:113] offset:2304
    ds_write_b64 v3, v[114:115] offset:2320
    ds_write_b64 v3, v[116:117] offset:2336
    ds_write_b64 v3, v[118:119] offset:2352
    s_mov_b64 exec, 1
    ds_add_u32 v26, v21 offset:26624
    s_mov_b64 exec, -1
    s_mul_i32 s70, s57, -9216
    s_add_u32 s70, s70, 4608
    v_add_u32 v17, s70, v7
    ds_read_b128 v[120:123], v26 offset:26656
L_sb13:
    ds_read_b32 v16, v26 offset:26624
    s_waitcnt lgkmcnt(0)
    v_readfirstlane_b32 s69, v16
    s_cmp_ge_u32 s69, 4
    s_cbranch_scc1 L_sbd14
    s_sub_u32 s68, s68, 1
    s_cbranch_scc1 L_sbd14_x
    s_sleep 1
    s_branch L_sb13
L_sbd14_x:
    s_mov_b32 s68, 0
L_sbd14:
    ds_read_b64_tr_b16 v[96:97], v7 offset:0
    ds_read_b64_tr_b16 v[98:99], v7 offset:576
    ds_read_b64_tr_b16 v[100:101], v7 offset:1152
    ds_read_b64_tr_b16 v[102:103], v7 offset:1728
    ds_read_b64_tr_b16 v[104:105], v17 offset:0
    ds_read_b64_tr_b16 v[106:107], v17 offset:576
    ds_read_b64_tr_b16 v[108:109], v17 offset:1152
    ds_read_b64_tr_b16 v[110:111], v17 offset:1728
    s_mov_b64 exec, 1
    ds_add_u32 v26, v21 offset:26624
    s_mov_b64 exec, -1
    s_mov_b64 exec, 0
    s_cmp_eq_u32 s78, 1
    s_cbranch_scc0 L_wk0
    s_call_b64 s[92:93], L_pg0
L_wk0:
    s_cmp_eq_u32 s78, 2
    s_cbranch_scc0 L_wk1
    s_call_b64 s[92:93], L_pg1
L_wk1:
    s_cmp_eq_u32 s78, 3
    s_cbranch_scc0 L_wk5
    s_call_b64 s[92:93], L_pg5
L_wk5:
    s_branch L_wdone
L_wret:
    s_setpc_b64 s[92:93]
L_wdone:
    s_mov_b64 exec, -1
L_sb15:
    ds_read_b32 v16, v26 offset:26624
    s_waitcnt lgkmcnt(0)
    v_readfirstlane_b32 s69, v16
    s_cmp_ge_u32 s69, 8
    s_cbranch_scc1 L_sbd16
    s_sub_u32 s68, s68, 1
    s_cbranch_scc1 L_sbd16_x
    s_sleep 1
    s_branch L_sb15
L_sbd16_x:
    s_mov_b32 s68, 0
L_sbd16:
L_sb17:
    ds_read_b32 v16, v26 offset:26628
    s_waitcnt lgkmcnt(0)
    v_readfirstlane_b32 s69, v16
    s_cmp_ge_u32 s69, 256
    s_cbranch_scc1 L_sbd18
    s_sub_u32 s68, s68, 1
    s_cbranch_scc1 L_sbd18_x
    s_sleep 3
    s_branch L_sb17
L_sbd18_x:
    s_mov_b32 s68, 0
L_sbd18:
    s_lshl1_add_u32 s5, s53, s57
    s_lshl_b32 s5, s5, 7
    s_add_u32 s5, s5, 147456
    s_mul_i32 s69, s57, 9216
    s_sub_u32 s5, s5, s69
    buffer_load_dword v11, v15, s[24:27], s5 offen sc1
    s_mul_i32 s69, s60, 196608
    s_add_u32 s69, s69, s77
    s_add_u32 s69, s69, 2048
    s_add_u32 m0, s59, 98304
    s_nop 0
    buffer_load_dwordx4 v5, s[12:15], s69 offen lds
    s_sub_u32 m0, m0, 4096
    s_nop 0
    buffer_load_dwordx4 v13, s[12:15], s69 offen lds
    s_mul_i32 s69, s61, 196608
    s_add_u32 s69, s69, s77
    s_add_u32 s69, s69, 2048
    s_add_u32 m0, s59, 106496
    s_nop 0
    buffer_load_dwordx4 v5, s[12:15], s69 offen lds
    s_sub_u32 m0, m0, 4096
    s_nop 0
    buffer_load_dwordx4 v13, s[12:15], s69 offen lds
    s_mov_b64 exec, 0
    s_cmp_eq_u32 s78, 1
    s_cbranch_scc0 L_wk2
    s_call_b64 s[92:93], L_pg2
L_wk2:
    s_cmp_eq_u32 s78, 2
    s_cbranch_scc0 L_wk3
    s_call_b64 s[92:93], L_pg3
L_wk3:
    s_cmp_eq_u32 s78, 3
    s_cbranch_scc0 L_wk6
    s_call_b64 s[92:93], L_pg6
L_wk6:
    s_mov_b64 exec, -1
    s_waitcnt vmcnt(4)
    s_branch L_gw19c
L_gw19:
    buffer_load_dword v11, v15, s[24:27], s5 offen sc1
    s_waitcnt vmcnt(0)
L_gw19c:
    v_cmp_eq_u32 vcc, -1, v11
    s_cbranch_vccz L_gwd20
    s_sub_u32 s68, s68, 1
    s_cbranch_scc1 L_gwd20_x
    s_sleep 2
    s_branch L_gw19
L_gwd20_x:
    s_mov_b32 s68, 0
L_gwd20:
    s_cmp_eq_u32 s78, 1
    s_cbranch_scc0 L_nog
    ds_write_b32 v14, v11 offset:17472
L_nog:
    s_cmp_eq_u32 s78, 0
    s_cbranch_scc0 L_nf21
    s_mov_b32 s80, 0
    s_call_b64 s[92:93], L_fin
L_nf21:
    s_waitcnt vmcnt(0)
    s_mov_b64 exec, 1
    ds_add_u32 v26, v21 offset:26624
    s_mov_b64 exec, -1
    s_mul_i32 s69, s62, 196608
    s_add_u32 s69, s69, s77
    s_add_u32 s69, s69, 2048
    s_add_u32 m0, s59, 114688
    s_nop 0
    buffer_load_dwordx4 v5, s[12:15], s69 offen lds
    s_sub_u32 m0, m0, 4096
    s_nop 0
    buffer_load_dwordx4 v13, s[12:15], s69 offen lds
    s_mul_i32 s69, s63, 196608
    s_add_u32 s69, s69, s77
    s_add_u32 s69, s69, 2048
    s_add_u32 m0, s59, 122880
    s_nop 0
    buffer_load_dwordx4 v5, s[12:15], s69 offen lds
    s_sub_u32 m0, m0, 4096
    s_nop 0
    buffer_load_dwordx4 v13, s[12:15], s69 offen lds
L_sb22:
    ds_read_b32 v16, v26 offset:26624
    s_waitcnt lgkmcnt(0)
    v_readfirstlane_b32 s69, v16
    s_cmp_ge_u32 s69, 12
    s_cbranch_scc1 L_sbd23
    s_sub_u32 s68, s68, 1
    s_cbranch_scc1 L_sbd23_x
    s_sleep 1
    s_branch L_sb22
L_sbd23_x:
    s_mov_b32 s68, 0
L_sbd23:
    s_setprio 0
    ds_read_b64_tr_b16 v[32:33], v19 offset:0
    ds_read_b64_tr_b16 v[34:35], v19 offset:512
    s_mul_i32 s69, s64, 196608
    s_add_u32 s69, s69, s77
    s_add_u32 s69, s69, 2048
    s_add_u32 m0, s59, 131072
    s_nop 0
    buffer_load_dwordx4 v5, s[12:15], s69 offen lds
    s_sub_u32 m0, m0, 4096
    s_nop 0
    buffer_load_dwordx4 v13, s[12:15], s69 offen lds
    s_waitcnt lgkmcnt(0)
    v_mfma_f32_32x32x16_bf16 v[64:79], a[0:3], v[32:35], 0
    ds_read_b64_tr_b16 v[36:37], v19 offset:2048
    ds_read_b64_tr_b16 v[38:39], v19 offset:2560
    s_waitcnt lgkmcnt(0)
    v_mfma_f32_32x32x16_bf16 v[64:79], a[4:7], v[36:39], v[64:79]
    ds_read_b64_tr_b16 v[40:41], v19 offset:4096
    ds_read_b64_tr_b16 v[42:43], v19 offset:4608
    s_mul_i32 s69, s65, 196608
    s_add_u32 s69, s69, s77
    s_add_u32 s69, s69, 2048
    s_add_u32 m0, s59, 139264
    s_nop 0
    buffer_load_dwordx4 v5, s[12:15], s69 offen lds
    s_sub_u32 m0, m0, 4096
    s_nop 0
    buffer_load_dwordx4 v13, s[12:15], s69 offen lds
    s_waitcnt lgkmcnt(0)
    v_mfma_f32_32x32x16_bf16 v[64:79], a[8:11], v[40:43], v[64:79]
    ds_read_b64_tr_b16 v[44:45], v19 offset:6144
    ds_read_b64_tr_b16 v[46:47], v19 offset:6656
    s_waitcnt lgkmcnt(0)
    v_mfma_f32_32x32x16_bf16 v[64:79], a[12:15], v[44:47], v[64:79]
    ds_read_b64_tr_b16 v[48:49], v19 offset:8192
    ds_read_b64_tr_b16 v[50:51], v19 offset:8704
    s_mul_i32 s69, s66, 196608
    s_add_u32 s69, s69, s77
    s_add_u32 s69, s69, 2048
    s_add_u32 m0, s59, 147456
    s_nop 0
    buffer_load_dwordx4 v5, s[12:15], s69 offen lds
    s_sub_u32 m0, m0, 4096
    s_nop 0
    buffer_load_dwordx4 v13, s[12:15], s69 offen lds
    s_waitcnt lgkmcnt(0)
    v_mfma_f32_32x32x16_bf16 v[64:79], a[16:19], v[48:51], v[64:79]
    ds_read_b64_tr_b16 v[32:33], v19 offset:10240
    ds_read_b64_tr_b16 v[34:35], v19 offset:10752
    s_waitcnt vmcnt(6)
    s_mov_b64 exec, 1
    ds_add_u32 v26, v21 offset:26624
    s_mov_b64 exec, -1
    s_waitcnt lgkmcnt(0)
    v_mfma_f32_32x32x16_bf16 v[64:79], a[20:23], v[32:35], v[64:79]
    ds_read_b64_tr_b16 v[36:37], v19 offset:12288
    ds_read_b64_tr_b16 v[38:39], v19 offset:12800
    s_mul_i32 s69, s67, 196608
    s_add_u32 s69, s69, s77
    s_add_u32 s69, s69, 2048
    s_add_u32 m0, s59, 155648
    s_nop 0
    buffer_load_dwordx4 v5, s[12:15], s69 offen lds
    s_sub_u32 m0, m0, 4096
    s_nop 0
    buffer_load_dwordx4 v13, s[12:15], s69 offen lds
    s_waitcnt lgkmcnt(0)
    v_mfma_f32_32x32x16_bf16 v[64:79], a[24:27], v[36:39], v[64:79]
    ds_read_b64_tr_b16 v[40:41], v19 offset:14336
    ds_read_b64_tr_b16 v[42:43], v19 offset:14848
    s_mul_i32 s3, s84, 17
    s_add_u32 s3, s3, s53
    s_lshl_b32 s3, s3, 7
    s_add_u32 s3, s3, 3407872
    s_lshl_b32 s4, s53, 7
    s_add_u32 s4, s4, s85
    s_waitcnt lgkmcnt(0)
    v_mfma_f32_32x32x16_bf16 v[64:79], a[28:31], v[40:43], v[64:79]
    s_setprio 2
L_sb24:
    ds_read_b32 v16, v26 offset:26624
    s_waitcnt lgkmcnt(0)
    v_readfirstlane_b32 s69, v16
    s_cmp_ge_u32 s69, 16
    s_cbranch_scc1 L_sbd25
    s_sub_u32 s68, s68, 1
    s_cbranch_scc1 L_sbd25_x
    s_sleep 1
    s_branch L_sb24
L_sbd25_x:
    s_mov_b32 s68, 0
L_sbd25:
    s_setprio 0
    ds_read_b64_tr_b16 v[44:45], v19 offset:16384
    ds_read_b64_tr_b16 v[46:47], v19 offset:16896
    s_mul_i32 s69, s60, 196608
    s_add_u32 s69, s69, s77
    s_add_u32 m0, s59, 32768
    s_nop 0
    buffer_load_dwordx4 v5, s[12:15], s69 offen lds
    s_sub_u32 m0, m0, 4096
    s_nop 0
    buffer_load_dwordx4 v13, s[12:15], s69 offen lds
    s_waitcnt lgkmcnt(0)
    v_mfma_f32_32x32x16_bf16 v[64:79], a[32:35], v[44:47], v[64:79]
    ds_read_b64_tr_b16 v[48:49], v19 offset:18432
    ds_read_b64_tr_b16 v[50:51], v19 offset:18944
    s_mul_i32 s69, s61, 196608
    s_add_u32 s69, s69, s77
    s_add_u32 m0, s59, 40960
    s_nop 0
    buffer_load_dwordx4 v5, s[12:15], s69 offen lds
    s_sub_u32 m0, m0, 4096
    s_nop 0
    buffer_load_dwordx4 v13, s[12:15], s69 offen lds
    s_waitcnt lgkmcnt(0)
    v_mfma_f32_32x32x16_bf16 v[64:79], a[36:39], v[48:51], v[64:79]
    ds_read_b64_tr_b16 v[32:33], v19 offset:20480
    ds_read_b64_tr_b16 v[34:35], v19 offset:20992
    buffer_store_dwordx4 v[120:123], v29, s[24:27], s4 offen sc1
    s_add_u32 s4, s4, 32768
    s_waitcnt lgkmcnt(0)
    v_mfma_f32_32x32x16_bf16 v[64:79], a[40:43], v[32:35], v[64:79]
    ds_read_b64_tr_b16 v[36:37], v19 offset:22528
    ds_read_b64_tr_b16 v[38:39], v19 offset:23040
    s_waitcnt vmcnt(5)
    s_mov_b64 exec, 1
    ds_add_u32 v26, v21 offset:26624
    s_mov_b64 exec, -1
    s_waitcnt lgkmcnt(0)
    v_mfma_f32_32x32x16_bf16 v[64:79], a[44:47], v[36:39], v[64:79]
    ds_read_b64_tr_b16 v[40:41], v19 offset:24576
    ds_read_b64_tr_b16 v[42:43], v19 offset:25088
    buffer_store_dwordx4 v[120:123], v29, s[24:27], s4 offen sc1
    s_add_u32 s4, s4, 32768
    s_waitcnt lgkmcnt(0)
    v_mfma_f32_32x32x16_bf16 v[64:79], a[48:51], v[40:43], v[64:79]
    ds_read_b64_tr_b16 v[44:45], v19 offset:26624
    ds_read_b64_tr_b16 v[46:47], v19 offset:27136
    s_mov_b64 exec, 0xff
    buffer_store_dwordx4 v[120:123], v29, s[24:27], s4 offen sc1
    s_cmp_gt_u32 s53, 16
    s_cbranch_scc1 L_nokf
    buffer_store_dwordx4 v[120:123], v1, s[24:27], s3 offen sc1
L_nokf:
    s_mov_b64 exec, -1
    s_waitcnt lgkmcnt(0)
    v_mfma_f32_32x32x16_bf16 v[64:79], a[52:55], v[44:47], v[64:79]
    ds_read_b64_tr_b16 v[48:49], v19 offset:28672
    ds_read_b64_tr_b16 v[50:51], v19 offset:29184
    s_cmp_ge_u32 s78, 2
    s_cbranch_scc0 L_nooa
    s_add_u32 s69, s81, 4194304
    buffer_store_dwordx4 v[120:123], v1, s[24:27], s69 offen offset:3072 sc1
L_nooa:
    s_cmp_eq_u32 s78, 0
    s_cbranch_scc0 L_nf0
    buffer_store_dwordx4 v[84:87], v1, s[24:27], s89 offen sc1
L_nf0:
    s_waitcnt lgkmcnt(0)
    v_mfma_f32_32x32x16_bf16 v[64:79], a[56:59], v[48:51], v[64:79]
    ds_read_b64_tr_b16 v[32:33], v19 offset:30720
    ds_read_b64_tr_b16 v[34:35], v19 offset:31232
    s_lshl_b32 s69, s58, 10
    s_add_u32 s69, s69, s81
    buffer_store_dwordx4 v[120:123], v1, s[24:27], s69 offen offset:2048 sc1
    s_waitcnt lgkmcnt(0)
    v_mfma_f32_32x32x16_bf16 v[64:79], a[60:63], v[32:35], v[64:79]
    s_setprio 2
L_sb26:
    ds_read_b32 v16, v26 offset:26624
    s_waitcnt lgkmcnt(0)
    v_readfirstlane_b32 s69, v16
    s_cmp_ge_u32 s69, 20
    s_cbranch_scc1 L_sbd27
    s_sub_u32 s68, s68, 1
    s_cbranch_scc1 L_sbd27_x
    s_sleep 1
    s_branch L_sb26
L_sbd27_x:
    s_mov_b32 s68, 0
L_sbd27:
    s_setprio 0
    ds_read_b64_tr_b16 v[36:37], v19 offset:32768
    ds_read_b64_tr_b16 v[38:39], v19 offset:33280
    s_waitcnt lgkmcnt(0)
    v_mfma_f32_32x32x16_bf16 v[64:79], a[64:67], v[36:39], v[64:79]
    ds_read_b64_tr_b16 v[40:41], v19 offset:34816
    ds_read_b64_tr_b16 v[42:43], v19 offset:35328
    s_mul_i32 s69, s62, 196608
    s_add_u32 s69, s69, s77
    s_add_u32 m0, s59, 49152
    s_nop 0
    buffer_load_dwordx4 v5, s[12:15], s69 offen lds
    s_sub_u32 m0, m0, 4096
    s_nop 0
    buffer_load_dwordx4 v13, s[12:15], s69 offen lds
    s_waitcnt lgkmcnt(0)
    v_mfma_f32_32x32x16_bf16 v[64:79], a[68:71], v[40:43], v[64:79]
    ds_read_b64_tr_b16 v[44:45], v19 offset:36864
    ds_read_b64_tr_b16 v[46:47], v19 offset:37376
    s_waitcnt lgkmcnt(0)
    v_mfma_f32_32x32x16_bf16 v[64:79], a[72:75], v[44:47], v[64:79]
    ds_read_b64_tr_b16 v[48:49], v19 offset:38912
    ds_read_b64_tr_b16 v[50:51], v19 offset:39424
    s_mul_i32 s69, s63, 196608
    s_add_u32 s69, s69, s77
    s_add_u32 m0, s59, 57344
    s_nop 0
    buffer_load_dwordx4 v5, s[12:15], s69 offen lds
    s_sub_u32 m0, m0, 4096
    s_nop 0
    buffer_load_dwordx4 v13, s[12:15], s69 offen lds
    s_waitcnt lgkmcnt(0)
    v_mfma_f32_32x32x16_bf16 v[64:79], a[76:79], v[48:51], v[64:79]
    ds_read_b64_tr_b16 v[32:33], v19 offset:40960
    ds_read_b64_tr_b16 v[34:35], v19 offset:41472
    s_waitcnt lgkmcnt(0)
    v_mfma_f32_32x32x16_bf16 v[64:79], a[80:83], v[32:35], v[64:79]
    ds_read_b64_tr_b16 v[36:37], v19 offset:43008
    ds_read_b64_tr_b16 v[38:39], v19 offset:43520
    s_mul_i32 s69, s64, 196608
    s_add_u32 s69, s69, s77
    s_add_u32 m0, s59, 65536
    s_nop 0
    buffer_load_dwordx4 v5, s[12:15], s69 offen lds
    s_sub_u32 m0, m0, 4096
    s_nop 0
    buffer_load_dwordx4 v13, s[12:15], s69 offen lds
    s_waitcnt lgkmcnt(0)
    v_mfma_f32_32x32x16_bf16 v[64:79], a[84:87], v[36:39], v[64:79]
    ds_read_b64_tr_b16 v[40:41], v19 offset:45056
    ds_read_b64_tr_b16 v[42:43], v19 offset:45568
    s_waitcnt lgkmcnt(0)
    v_mfma_f32_32x32x16_bf16 v[64:79], a[88:91], v[40:43], v[64:79]
    ds_read_b64_tr_b16 v[44:45], v19 offset:47104
    ds_read_b64_tr_b16 v[46:47], v19 offset:47616
    s_mul_i32 s69, s65, 196608
    s_add_u32 s69, s69, s77
    s_add_u32 m0, s59, 73728
    s_nop 0
    buffer_load_dwordx4 v5, s[12:15], s69 offen lds
    s_sub_u32 m0, m0, 4096
    s_nop 0
    buffer_load_dwordx4 v13, s[12:15], s69 offen lds
    s_waitcnt lgkmcnt(0)
    v_mfma_f32_32x32x16_bf16 v[64:79], a[92:95], v[44:47], v[64:79]
    ds_read_b64_tr_b16 v[48:49], v19 offset:49152
    ds_read_b64_tr_b16 v[50:51], v19 offset:49664
    s_waitcnt lgkmcnt(0)
    v_mfma_f32_32x32x16_bf16 v[64:79], a[96:99], v[48:51], v[64:79]
    ds_read_b64_tr_b16 v[32:33], v19 offset:51200
    ds_read_b64_tr_b16 v[34:35], v19 offset:51712
    s_mul_i32 s69, s66, 196608
    s_add_u32 s69, s69, s77
    s_add_u32 m0, s59, 81920
    s_nop 0
    buffer_load_dwordx4 v5, s[12:15], s69 offen lds
    s_sub_u32 m0, m0, 4096
    s_nop 0
    buffer_load_dwordx4 v13, s[12:15], s69 offen lds
    s_waitcnt lgkmcnt(0)
    v_mfma_f32_32x32x16_bf16 v[64:79], a[100:103], v[32:35], v[64:79]
    ds_read_b64_tr_b16 v[36:37], v19 offset:53248
    ds_read_b64_tr_b16 v[38:39], v19 offset:53760
    s_waitcnt lgkmcnt(0)
    v_mfma_f32_32x32x16_bf16 v[64:79], a[104:107], v[36:39], v[64:79]
    ds_read_b64_tr_b16 v[40:41], v19 offset:55296
    ds_read_b64_tr_b16 v[42:43], v19 offset:55808
    s_mul_i32 s69, s67, 196608
    s_add_u32 s69, s69, s77
    s_add_u32 m0, s59, 90112
    s_nop 0
    buffer_load_dwordx4 v5, s[12:15], s69 offen lds
    s_sub_u32 m0, m0, 4096
    s_nop 0
    buffer_load_dwordx4 v13, s[12:15], s69 offen lds
    s_waitcnt lgkmcnt(0)
    v_mfma_f32_32x32x16_bf16 v[64:79], a[108:111], v[40:43], v[64:79]
    ds_read_b64_tr_b16 v[44:45], v19 offset:57344
    ds_read_b64_tr_b16 v[46:47], v19 offset:57856
    s_waitcnt vmcnt(12)
    s_mov_b64 exec, 1
    buffer_store_dword v21, v26, s[24:27], s79 offen offset:0 sc1
    s_mov_b64 exec, -1
    s_waitcnt lgkmcnt(0)
    v_mfma_f32_32x32x16_bf16 v[64:79], a[112:115], v[44:47], v[64:79]
    ds_read_b64_tr_b16 v[48:49], v19 offset:59392
    ds_read_b64_tr_b16 v[50:51], v19 offset:59904
    s_waitcnt lgkmcnt(0)
    v_mfma_f32_32x32x16_bf16 v[64:79], a[116:119], v[48:51], v[64:79]
    ds_read_b64_tr_b16 v[32:33], v19 offset:61440
    ds_read_b64_tr_b16 v[34:35], v19 offset:61952
    s_waitcnt lgkmcnt(0)
    v_mfma_f32_32x32x16_bf16 v[64:79], a[120:123], v[32:35], v[64:79]
    ds_read_b64_tr_b16 v[36:37], v19 offset:63488
    ds_read_b64_tr_b16 v[38:39], v19 offset:64000
    s_waitcnt lgkmcnt(0)
    v_mfma_f32_32x32x16_bf16 v[64:79], a[124:127], v[36:39], v[64:79]
    s_setprio 2
    ds_read_b128 v[120:123], v26 offset:26640
    ds_read_b128 v[124:127], v26 offset:26640
    s_lshl_b32 s69, s57, 4
    s_lshl_b32 s82, 0xffff, s69
    s_mov_b32 s83, s82
    s_nop 5
    v_cvt_pk_bf16_f32 v112, v64, v65
    v_cvt_pk_bf16_f32 v113, v66, v67
    v_cvt_pk_bf16_f32 v114, v68, v69
    v_cvt_pk_bf16_f32 v115, v70, v71
    v_cvt_pk_bf16_f32 v116, v72, v73
    v_cvt_pk_bf16_f32 v117, v74, v75
    v_cvt_pk_bf16_f32 v118, v76, v77
    v_cvt_pk_bf16_f32 v119, v78, v79
    s_not_b64 exec, s[82:83]
    ds_write_b128 v23, v[112:115] offset:0
    ds_write_b128 v23, v[116:119] offset:512
    ds_read_b128 v[112:115], v26 offset:26640
    ds_read_b128 v[116:119], v26 offset:26640
    s_mov_b64 exec, -1
    s_mov_b64 exec, 1
    ds_add_u32 v26, v21 offset:26624
    s_mov_b64 exec, -1
    s_waitcnt lgkmcnt(0)
    s_setprio 0
    v_mfma_f32_32x32x16_bf16 v[64:79], v[96:99], v[112:115], 0
    v_mfma_f32_32x32x16_bf16 v[64:79], v[100:103], v[116:119], v[64:79]
    s_setprio 2
L_sb28:
    ds_read_b32 v16, v26 offset:26624
    s_waitcnt lgkmcnt(0)
    v_readfirstlane_b32 s69, v16
    s_cmp_ge_u32 s69, 24
    s_cbranch_scc1 L_sbd29
    s_sub_u32 s68, s68, 1
    s_cbranch_scc1 L_sbd29_x
    s_branch L_sb28
L_sbd29_x:
    s_mov_b32 s68, 0
L_sbd29:
    s_mov_b64 exec, s[82:83]
    ds_read_b128 v[120:123], v24 offset:0
    ds_read_b128 v[124:127], v24 offset:512
    s_mov_b64 exec, -1
    s_setprio 0
    s_waitcnt lgkmcnt(0)
    v_mfma_f32_32x32x16_bf16 v[64:79], v[104:107], v[120:123], v[64:79]
    v_mfma_f32_32x32x16_bf16 v[64:79], v[108:111], v[124:127], v[64:79]
    s_setprio 2
    s_nop 10
    ds_write_b128 v28, v[64:67] offset:36864
    ds_write_b128 v28, v[68:71] offset:36880
    ds_write_b128 v28, v[72:75] offset:36896
    ds_write_b128 v28, v[76:79] offset:36912
    ds_read_b128 v[96:99], v30 offset:36864
    ds_read_b128 v[100:103], v30 offset:38016
    ds_read_b128 v[104:107], v30 offset:39168
    s_waitcnt lgkmcnt(0)
    s_lshl_b32 s70, s53, 7
    s_add_u32 s70, s70, s85
    buffer_store_dwordx4 v[96:99], v29, s[24:27], s70 offen sc1
    s_add_u32 s70, s70, 32768
    buffer_store_dwordx4 v[100:103], v29, s[24:27], s70 offen sc1
    s_add_u32 s70, s70, 32768
    s_mov_b64 exec, 0xff
    buffer_store_dwordx4 v[104:107], v29, s[24:27], s70 offen sc1
    s_mov_b64 exec, -1
    s_waitcnt vmcnt(4)
    s_mov_b64 exec, 1
    ds_add_u32 v26, v21 offset:26624
    s_mov_b64 exec, -1
    s_lshl_b32 s73, s86, 8
    s_add_u32 s73, s73, 262144
    buffer_load_dword v5, v6, s[24:27], s73 offen sc1
    buffer_load_dword v13, v26, s[24:27], s73 offen sc1
    s_cmp_eq_u32 s78, 1
    s_cbranch_scc0 L_nf30
    s_mov_b32 s80, 1
    s_call_b64 s[92:93], L_fin
    buffer_store_dwordx4 v[84:87], v1, s[24:27], s89 offen sc1
    s_nop 0
L_nf30:
    s_cmp_eq_u32 s78, 2
    s_cbranch_scc0 L_nf31
    s_mov_b32 s80, 2
    s_call_b64 s[92:93], L_fin
    buffer_store_dwordx4 v[84:87], v1, s[24:27], s89 offen sc1
    s_nop 0
L_nf31:
L_sb32:
    ds_read_b32 v16, v26 offset:26624
    s_waitcnt lgkmcnt(0)
    v_readfirstlane_b32 s69, v16
    s_cmp_ge_u32 s69, 28
    s_cbranch_scc1 L_sbd33
    s_sub_u32 s68, s68, 1
    s_cbranch_scc1 L_sbd33_x
    s_sleep 1
    s_branch L_sb32
L_sbd33_x:
    s_mov_b32 s68, 0
L_sbd33:
    s_lshl_b32 s4, s53, 12
    s_add_u32 s4, s4, s85
    s_setprio 0
    ds_read_b64_tr_b16 v[32:33], v18 offset:0
    ds_read_b64_tr_b16 v[34:35], v18 offset:512
    s_waitcnt lgkmcnt(0)
    v_mfma_f32_32x32x16_bf16 v[64:79], v[32:35], a[0:3], 0
    ds_read_b64_tr_b16 v[36:37], v18 offset:2048
    ds_read_b64_tr_b16 v[38:39], v18 offset:2560
    s_waitcnt lgkmcnt(0)
    v_mfma_f32_32x32x16_bf16 v[64:79], v[36:39], a[4:7], v[64:79]
    ds_read_b64_tr_b16 v[40:41], v18 offset:4096
    ds_read_b64_tr_b16 v[42:43], v18 offset:4608
    s_waitcnt lgkmcnt(0)
    v_mfma_f32_32x32x16_bf16 v[64:79], v[40:43], a[8:11], v[64:79]
L_pg5:
    s_cbranch_execz L_wret
    ds_read_b64_tr_b16 v[44:45], v18 offset:6144
    ds_read_b64_tr_b16 v[46:47], v18 offset:6656
    s_waitcnt lgkmcnt(0)
    v_mfma_f32_32x32x16_bf16 v[64:79], v[44:47], a[12:15], v[64:79]
    ds_read_b64_tr_b16 v[48:49], v18 offset:8192
    ds_read_b64_tr_b16 v[50:51], v18 offset:8704
    s_waitcnt lgkmcnt(0)
    v_mfma_f32_32x32x16_bf16 v[64:79], v[48:51], a[16:19], v[64:79]
    ds_read_b64_tr_b16 v[32:33], v18 offset:10240
    ds_read_b64_tr_b16 v[34:35], v18 offset:10752
    s_waitcnt lgkmcnt(0)
    v_mfma_f32_32x32x16_bf16 v[64:79], v[32:35], a[20:23], v[64:79]
    ds_read_b64_tr_b16 v[36:37], v18 offset:12288
    ds_read_b64_tr_b16 v[38:39], v18 offset:12800
    s_waitcnt lgkmcnt(0)
    v_mfma_f32_32x32x16_bf16 v[64:79], v[36:39], a[24:27], v[64:79]
    ds_read_b64_tr_b16 v[40:41], v18 offset:14336
    ds_read_b64_tr_b16 v[42:43], v18 offset:14848
    s_waitcnt lgkmcnt(0)
    v_mfma_f32_32x32x16_bf16 v[64:79], v[40:43], a[28:31], v[64:79]
    ds_read_b64_tr_b16 v[44:45], v18 offset:16384
    ds_read_b64_tr_b16 v[46:47], v18 offset:16896
    s_setprio 2
    s_waitcnt vmcnt(1)
    v_cmp_ne_u32 vcc, 1, v5
    s_cbranch_vccz L_fl34
L_pl35:
    buffer_load_dword v16, v6, s[24:27], s73 offen sc1
    s_waitcnt vmcnt(0)
    v_cmp_ne_u32 vcc, 1, v16
    s_cbranch_vccz L_pld36
    s_sub_u32 s68, s68, 1
    s_cbranch_scc1 L_pld36_x
    s_sleep 2
    s_branch L_pl35
L_pld36_x:
    s_mov_b32 s68, 0
L_pld36:
L_fl34:
    s_setprio 0
    s_cmp_gt_u32 s53, 16
    s_cbranch_scc1 L_noal
    buffer_load_dwordx4 v[80:83], v1, s[24:27], s4 offen offset:0 sc1
    buffer_load_dwordx4 v[84:87], v1, s[24:27], s4 offen offset:1024 sc1
    buffer_load_dwordx4 v[88:91], v1, s[24:27], s4 offen offset:2048 sc1
    buffer_load_dwordx4 v[92:95], v1, s[24:27], s4 offen offset:3072 sc1
L_noal:
    s_waitcnt lgkmcnt(0)
    v_mfma_f32_32x32x16_bf16 v[64:79], v[44:47], a[32:35], v[64:79]
    ds_read_b64_tr_b16 v[48:49], v18 offset:18432
    ds_read_b64_tr_b16 v[50:51], v18 offset:18944
    s_waitcnt lgkmcnt(0)
    v_mfma_f32_32x32x16_bf16 v[64:79], v[48:51], a[36:39], v[64:79]
    ds_read_b64_tr_b16 v[32:33], v18 offset:20480
    ds_read_b64_tr_b16 v[34:35], v18 offset:20992
    s_waitcnt lgkmcnt(0)
    v_mfma_f32_32x32x16_bf16 v[64:79], v[32:35], a[40:43], v[64:79]
    ds_read_b64_tr_b16 v[36:37], v18 offset:22528
    ds_read_b64_tr_b16 v[38:39], v18 offset:23040
    s_waitcnt lgkmcnt(0)
    v_mfma_f32_32x32x16_bf16 v[64:79], v[36:39], a[44:47], v[64:79]
    ds_read_b64_tr_b16 v[40:41], v18 offset:24576
    ds_read_b64_tr_b16 v[42:43], v18 offset:25088
    s_waitcnt lgkmcnt(0)
    v_mfma_f32_32x32x16_bf16 v[64:79], v[40:43], a[48:51], v[64:79]
    ds_read_b64_tr_b16 v[44:45], v18 offset:26624
    ds_read_b64_tr_b16 v[46:47], v18 offset:27136
    s_waitcnt lgkmcnt(0)
    v_mfma_f32_32x32x16_bf16 v[64:79], v[44:47], a[52:55], v[64:79]
    ds_read_b64_tr_b16 v[48:49], v18 offset:28672
    ds_read_b64_tr_b16 v[50:51], v18 offset:29184
    s_waitcnt lgkmcnt(0)
    v_mfma_f32_32x32x16_bf16 v[64:79], v[48:51], a[56:59], v[64:79]
    ds_read_b64_tr_b16 v[32:33], v18 offset:30720
    ds_read_b64_tr_b16 v[34:35], v18 offset:31232
    s_waitcnt lgkmcnt(0)
    v_mfma_f32_32x32x16_bf16 v[64:79], v[32:35], a[60:63], v[64:79]
    ds_read_b64_tr_b16 v[36:37], v18 offset:32768
    ds_read_b64_tr_b16 v[38:39], v18 offset:33280
    s_setprio 2
    s_cmp_gt_u32 s53, 16
    s_cbranch_scc1 L_noA
    s_branch L_sa37c
L_sa37:
    buffer_load_dwordx4 v[80:83], v1, s[24:27], s4 offen offset:0 sc1
    buffer_load_dwordx4 v[84:87], v1, s[24:27], s4 offen offset:1024 sc1
    buffer_load_dwordx4 v[88:91], v1, s[24:27], s4 offen offset:2048 sc1
    buffer_load_dwordx4 v[92:95], v1, s[24:27], s4 offen offset:3072 sc1
L_sa37c:
    s_waitcnt vmcnt(0)
    v_max3_u32 v16, v80, v81, v82
    v_max3_u32 v16, v16, v83, v84
    v_max3_u32 v16, v16, v85, v86
    v_max3_u32 v16, v16, v87, v88
    v_max3_u32 v16, v16, v89, v90
    v_max3_u32 v16, v16, v91, v92
    v_max3_u32 v16, v16, v93, v94
    v_max_u32 v16, v16, v95
    v_cmp_eq_u32 vcc, -1, v16
    s_cbranch_vccz L_sad38
    s_sub_u32 s68, s68, 1
    s_cbranch_scc1 L_sad38_x
    s_sleep 3
    s_branch L_sa37
L_sad38_x:
    s_mov_b32 s68, 0
L_sad38:
    v_pk_add_f32 v[80:81], v[80:81], v[84:85]
    v_pk_add_f32 v[82:83], v[82:83], v[86:87]
    v_pk_add_f32 v[88:89], v[88:89], v[92:93]
    v_pk_add_f32 v[90:91], v[90:91], v[94:95]
    v_pk_add_f32 v[80:81], v[80:81], v[88:89]
    v_pk_add_f32 v[82:83], v[82:83], v[90:91]
    s_nop 1
    v_permlane32_swap_b32 v80, v81
    v_permlane32_swap_b32 v82, v83
    v_add_f32 v80, v80, v81
    v_add_f32 v82, v82, v83
    s_nop 1
    v_permlane16_swap_b32 v80, v82
    v_add_f32 v80, v80, v82
    s_nop 1
    v_add_f32_dpp v80, v80, v80 row_ror:8 row_mask:0xf bank_mask:0xf
    v_cvt_pk_bf16_f32 v17, v80, v80
    buffer_store_short v17, v9, s[24:27], s3 offen sc1
L_noA:
    s_setprio 0
    s_mul_i32 s69, s60, 65536
    s_add_u32 s69, s69, s55
    s_lshl_b32 s70, s60, 13
    s_add_u32 s70, s70, s59
    s_add_u32 m0, s70, 98304
    s_nop 0
    buffer_load_dwordx4 v4, s[40:43], s69 offen lds
    s_sub_u32 m0, m0, 4096
    s_nop 0
    buffer_load_dwordx4 v12, s[40:43], s69 offen lds
    s_waitcnt lgkmcnt(0)
    v_mfma_f32_32x32x16_bf16 v[64:79], v[36:39], a[64:67], v[64:79]
    ds_read_b64_tr_b16 v[40:41], v18 offset:34816
    ds_read_b64_tr_b16 v[42:43], v18 offset:35328
    s_waitcnt lgkmcnt(0)
    v_mfma_f32_32x32x16_bf16 v[64:79], v[40:43], a[68:71], v[64:79]
    ds_read_b64_tr_b16 v[44:45], v18 offset:36864
    ds_read_b64_tr_b16 v[46:47], v18 offset:37376
    s_mul_i32 s69, s61, 65536
    s_add_u32 s69, s69, s55
    s_lshl_b32 s70, s61, 13
    s_add_u32 s70, s70, s59
    s_add_u32 m0, s70, 98304
    s_nop 0
    buffer_load_dwordx4 v4, s[40:43], s69 offen lds
    s_sub_u32 m0, m0, 4096
    s_nop 0
    buffer_load_dwordx4 v12, s[40:43], s69 offen lds
    s_waitcnt lgkmcnt(0)
    v_mfma_f32_32x32x16_bf16 v[64:79], v[44:47], a[72:75], v[64:79]
    ds_read_b64_tr_b16 v[48:49], v18 offset:38912
    ds_read_b64_tr_b16 v[50:51], v18 offset:39424
    s_waitcnt lgkmcnt(0)
    v_mfma_f32_32x32x16_bf16 v[64:79], v[48:51], a[76:79], v[64:79]
    ds_read_b64_tr_b16 v[32:33], v18 offset:40960
    ds_read_b64_tr_b16 v[34:35], v18 offset:41472
    s_mul_i32 s69, s62, 65536
    s_add_u32 s69, s69, s55
    s_lshl_b32 s70, s62, 13
    s_add_u32 s70, s70, s59
    s_add_u32 m0, s70, 98304
    s_nop 0
    buffer_load_dwordx4 v4, s[40:43], s69 offen lds
    s_sub_u32 m0, m0, 4096
    s_nop 0
    buffer_load_dwordx4 v12, s[40:43], s69 offen lds
    s_waitcnt lgkmcnt(0)
    v_mfma_f32_32x32x16_bf16 v[64:79], v[32:35], a[80:83], v[64:79]
    ds_read_b64_tr_b16 v[36:37], v18 offset:43008
    ds_read_b64_tr_b16 v[38:39], v18 offset:43520
    s_waitcnt lgkmcnt(0)
    v_mfma_f32_32x32x16_bf16 v[64:79], v[36:39], a[84:87], v[64:79]
    ds_read_b64_tr_b16 v[40:41], v18 offset:45056
    ds_read_b64_tr_b16 v[42:43], v18 offset:45568
    s_mul_i32 s69, s63, 65536
    s_add_u32 s69, s69, s55
    s_lshl_b32 s70, s63, 13
    s_add_u32 s70, s70, s59
    s_add_u32 m0, s70, 98304
    s_nop 0
    buffer_load_dwordx4 v4, s[40:43], s69 offen lds
    s_sub_u32 m0, m0, 4096
    s_nop 0
    buffer_load_dwordx4 v12, s[40:43], s69 offen lds
    s_waitcnt lgkmcnt(0)
    v_mfma_f32_32x32x16_bf16 v[64:79], v[40:43], a[88:91], v[64:79]
    ds_read_b64_tr_b16 v[44:45], v18 offset:47104
    ds_read_b64_tr_b16 v[46:47], v18 offset:47616
    s_waitcnt lgkmcnt(0)
    v_mfma_f32_32x32x16_bf16 v[64:79], v[44:47], a[92:95], v[64:79]
    ds_read_b64_tr_b16 v[48:49], v18 offset:49152
    ds_read_b64_tr_b16 v[50:51], v18 offset:49664
    s_mul_i32 s69, s64, 65536
    s_add_u32 s69, s69, s55
    s_lshl_b32 s70, s64, 13
    s_add_u32 s70, s70, s59
    s_add_u32 m0, s70, 98304
    s_nop 0
    buffer_load_dwordx4 v4, s[40:43], s69 offen lds
    s_sub_u32 m0, m0, 4096
    s_nop 0
    buffer_load_dwordx4 v12, s[40:43], s69 offen lds
    s_waitcnt lgkmcnt(0)
    v_mfma_f32_32x32x16_bf16 v[64:79], v[48:51], a[96:99], v[64:79]
    ds_read_b64_tr_b16 v[32:33], v18 offset:51200
    ds_read_b64_tr_b16 v[34:35], v18 offset:51712
    s_waitcnt lgkmcnt(0)
    v_mfma_f32_32x32x16_bf16 v[64:79], v[32:35], a[100:103], v[64:79]
    ds_read_b64_tr_b16 v[36:37], v18 offset:53248
    ds_read_b64_tr_b16 v[38:39], v18 offset:53760
    s_mul_i32 s69, s65, 65536
    s_add_u32 s69, s69, s55
    s_lshl_b32 s70, s65, 13
    s_add_u32 s70, s70, s59
    s_add_u32 m0, s70, 98304
    s_nop 0
    buffer_load_dwordx4 v4, s[40:43], s69 offen lds
    s_sub_u32 m0, m0, 4096
    s_nop 0
    buffer_load_dwordx4 v12, s[40:43], s69 offen lds
    s_waitcnt lgkmcnt(0)
    v_mfma_f32_32x32x16_bf16 v[64:79], v[36:39], a[104:107], v[64:79]
    ds_read_b64_tr_b16 v[40:41], v18 offset:55296
    ds_read_b64_tr_b16 v[42:43], v18 offset:55808
    s_waitcnt lgkmcnt(0)
    v_mfma_f32_32x32x16_bf16 v[64:79], v[40:43], a[108:111], v[64:79]
    ds_read_b64_tr_b16 v[44:45], v18 offset:57344
    ds_read_b64_tr_b16 v[46:47], v18 offset:57856
    s_mul_i32 s69, s66, 65536
    s_add_u32 s69, s69, s55
    s_lshl_b32 s70, s66, 13
    s_add_u32 s70, s70, s59
    s_add_u32 m0, s70, 98304
    s_nop 0
    buffer_load_dwordx4 v4, s[40:43], s69 offen lds
    s_sub_u32 m0, m0, 4096
    s_nop 0
    buffer_load_dwordx4 v12, s[40:43], s69 offen lds
    s_waitcnt lgkmcnt(0)
    v_mfma_f32_32x32x16_bf16 v[64:79], v[44:47], a[112:115], v[64:79]
    ds_read_b64_tr_b16 v[48:49], v18 offset:59392
    ds_read_b64_tr_b16 v[50:51], v18 offset:59904
    s_waitcnt lgkmcnt(0)
    v_mfma_f32_32x32x16_bf16 v[64:79], v[48:51], a[116:119], v[64:79]
    ds_read_b64_tr_b16 v[32:33], v18 offset:61440
    ds_read_b64_tr_b16 v[34:35], v18 offset:61952
    s_mul_i32 s69, s67, 65536
    s_add_u32 s69, s69, s55
    s_lshl_b32 s70, s67, 13
    s_add_u32 s70, s70, s59
    s_add_u32 m0, s70, 98304
    s_nop 0
    buffer_load_dwordx4 v4, s[40:43], s69 offen lds
    s_sub_u32 m0, m0, 4096
    s_nop 0
    buffer_load_dwordx4 v12, s[40:43], s69 offen lds
    s_waitcnt lgkmcnt(0)
    v_mfma_f32_32x32x16_bf16 v[64:79], v[32:35], a[120:123], v[64:79]
    ds_read_b64_tr_b16 v[36:37], v18 offset:63488
    ds_read_b64_tr_b16 v[38:39], v18 offset:64000
    s_waitcnt lgkmcnt(0)
    v_mfma_f32_32x32x16_bf16 v[64:79], v[36:39], a[124:127], v[64:79]
    s_setprio 2
    s_nop 2
    ds_read_b64_tr_b16 v[40:41], v0 offset:26944
    ds_read_b64_tr_b16 v[42:43], v0 offset:27200
    ds_read_b64_tr_b16 v[44:45], v0 offset:27456
    ds_read_b64_tr_b16 v[46:47], v0 offset:27712
    s_nop 4
    v_cvt_pk_bf16_f32 v56, v64, v65
    v_cvt_pk_bf16_f32 v57, v66, v67
    v_cvt_pk_bf16_f32 v58, v68, v69
    v_cvt_pk_bf16_f32 v59, v70, v71
    v_cvt_pk_bf16_f32 v60, v72, v73
    v_cvt_pk_bf16_f32 v61, v74, v75
    v_cvt_pk_bf16_f32 v62, v76, v77
    v_cvt_pk_bf16_f32 v63, v78, v79
    s_waitcnt lgkmcnt(0)
    s_setprio 0
    v_mfma_f32_32x32x16_bf16 v[96:111], v[40:43], v[56:59], 0
    v_mfma_f32_32x32x16_bf16 v[112:127], v[44:47], v[60:63], 0
    s_setprio 2
    s_nop 10
    s_cmp_eq_u32 s78, 3
    s_cbranch_scc0 L_nf39
    s_mov_b32 s80, 3
    s_call_b64 s[92:93], L_fin
L_nf39:
    ds_read_b128 v[32:35], v26 offset:26640
    ds_read_b128 v[36:39], v26 offset:26640
    ds_read_b128 v[40:43], v26 offset:26640
    ds_read_b128 v[44:47], v26 offset:26640
    s_mul_i32 s73, s86, 4352
    s_add_u32 s73, s73, 3407872
    s_mov_b32 s82, 0x5555ffff
    s_mov_b32 s83, 0x5555ffff
    s_waitcnt lgkmcnt(0)
    s_mov_b64 exec, s[82:83]
    buffer_load_dwordx4 v[32:35], v10, s[24:27], s73 offen offset:0 sc1
    buffer_load_dwordx4 v[36:39], v10, s[24:27], s73 offen offset:32 sc1
    buffer_load_dwordx4 v[40:43], v10, s[24:27], s73 offen offset:2176 sc1
    buffer_load_dwordx4 v[44:47], v10, s[24:27], s73 offen offset:2208 sc1
    s_mov_b64 exec, -1
    v_max3_f32 v16, |v96|, |v97|, |v98|
    v_max3_f32 v16, v16, |v99|, |v100|
    v_max3_f32 v16, v16, |v101|, |v102|
    v_max3_f32 v16, v16, |v103|, |v112|
    v_max3_f32 v16, v16, |v113|, |v114|
    v_max3_f32 v16, v16, |v115|, |v116|
    v_max3_f32 v16, v16, |v117|, |v118|
    v_max_f32 v16, v16, |v119|
    v_cmp_lt_f32 vcc, 0x41f00000, v16
    s_cbranch_vccz L_sx40
    s_call_b64 s[92:93], L_smx
    s_branch L_sxd41
L_sx40:
    v_exp_f32 v104, -v96
    v_exp_f32 v96, v96
    v_exp_f32 v105, -v97
    v_exp_f32 v97, v97
    v_exp_f32 v106, -v98
    v_exp_f32 v98, v98
    v_exp_f32 v107, -v99
    v_exp_f32 v99, v99
    v_exp_f32 v108, -v100
    v_exp_f32 v100, v100
    v_exp_f32 v109, -v101
    v_exp_f32 v101, v101
    v_exp_f32 v110, -v102
    v_exp_f32 v102, v102
    v_exp_f32 v111, -v103
    v_exp_f32 v103, v103
    v_exp_f32 v120, -v112
    v_exp_f32 v112, v112
    v_exp_f32 v121, -v113
    v_exp_f32 v113, v113
    v_exp_f32 v122, -v114
    v_exp_f32 v114, v114
    v_exp_f32 v123, -v115
    v_exp_f32 v115, v115
    v_exp_f32 v124, -v116
    v_exp_f32 v116, v116
    v_exp_f32 v125, -v117
    v_exp_f32 v117, v117
    v_exp_f32 v126, -v118
    v_exp_f32 v118, v118
    v_exp_f32 v127, -v119
    v_exp_f32 v119, v119
L_sxd41:
    s_branch L_sbk42c
L_sbk42:
    s_mov_b64 exec, s[82:83]
    buffer_load_dwordx4 v[32:35], v10, s[24:27], s73 offen offset:0 sc1
    buffer_load_dwordx4 v[36:39], v10, s[24:27], s73 offen offset:32 sc1
    buffer_load_dwordx4 v[40:43], v10, s[24:27], s73 offen offset:2176 sc1
    buffer_load_dwordx4 v[44:47], v10, s[24:27], s73 offen offset:2208 sc1
    s_mov_b64 exec, -1
L_sbk42c:
    s_waitcnt vmcnt(0)
    v_pk_max_u16 v16, v32, v33
    v_pk_max_u16 v16, v16, v34
    v_pk_max_u16 v16, v16, v35
    v_pk_max_u16 v16, v16, v36
    v_pk_max_u16 v16, v16, v37
    v_pk_max_u16 v16, v16, v38
    v_pk_max_u16 v16, v16, v39
    v_pk_max_u16 v16, v16, v40
    v_pk_max_u16 v16, v16, v41
    v_pk_max_u16 v16, v16, v42
    v_pk_max_u16 v16, v16, v43
    v_pk_max_u16 v16, v16, v44
    v_pk_max_u16 v16, v16, v45
    v_pk_max_u16 v16, v16, v46
    v_pk_max_u16 v16, v16, v47
    v_pk_max_u16 v16, v16, v16 op_sel:[0,1] op_sel_hi:[1,0]
    v_cmp_eq_u32 vcc, -1, v16
    s_cbranch_vccz L_sbkd43
    s_sub_u32 s68, s68, 1
    s_cbranch_scc1 L_sbkd43_x
    s_sleep 2
    s_branch L_sbk42
L_sbkd43_x:
    s_mov_b32 s68, 0
L_sbkd43:
    s_cmp_eq_u32 s78, 3
    s_cbranch_scc0 L_nf3
    buffer_store_dwordx4 v[84:87], v1, s[24:27], s89 offen sc1
L_nf3:
    s_mov_b64 exec, 1
    ds_add_u32 v26, v21 offset:26624
    s_mov_b64 exec, -1
    s_lshl_b32 s71, s86, 11
    s_add_u32 s70, s88, s71
    s_add_u32 s70, s70, 2097152
    s_mov_b32 s71, 897988541
    v_sub_f32 v60, 1.0, v11
    s_add_u32 s6, s87, 131072
    ds_read_b128 v[64:67], v26 offset:26672
    ds_read_b128 v[68:71], v26 offset:26672
    ds_read_b128 v[72:75], v26 offset:26672
    ds_read_b128 v[80:83], v26 offset:26672
    ds_read_b128 v[84:87], v26 offset:26672
    ds_read_b128 v[88:91], v26 offset:26672
    s_setprio 0
    s_waitcnt lgkmcnt(3)
    v_smfmac_f32_32x32x32_bf16 v[64:79], v[32:35], v[96:103], v25
    s_waitcnt lgkmcnt(0)
    v_smfmac_f32_32x32x32_bf16 v[80:95], v[36:39], v[104:111], v25
    s_setprio 2
    s_nop 10
    v_rcp_f32 v56, v73
    v_rcp_f32 v57, v89
    v_fma_f32 v58, v72, v56, s71
    v_fmac_f32 v58, v88, v57
    v_rcp_f32 v58, v58
    s_nop 0
    v_mul_f32 v58, v58, v60
    v_pk_mul_f32 v[56:57], v[56:57], v[58:59] op_sel_hi:[1,0]
    v_pk_mul_f32 v[64:65], v[64:65], v[56:57] op_sel_hi:[1,0]
    v_pk_mul_f32 v[66:67], v[66:67], v[56:57] op_sel_hi:[1,0]
    v_pk_mul_f32 v[68:69], v[68:69], v[56:57] op_sel_hi:[1,0]
    v_pk_mul_f32 v[70:71], v[70:71], v[56:57] op_sel_hi:[1,0]
    v_pk_fma_f32 v[64:65], v[80:81], v[56:57], v[64:65] op_sel:[0,1,0] op_sel_hi:[1,1,1]
    v_pk_fma_f32 v[66:67], v[82:83], v[56:57], v[66:67] op_sel:[0,1,0] op_sel_hi:[1,1,1]
    v_pk_fma_f32 v[68:69], v[84:85], v[56:57], v[68:69] op_sel:[0,1,0] op_sel_hi:[1,1,1]
    v_pk_fma_f32 v[70:71], v[86:87], v[56:57], v[70:71] op_sel:[0,1,0] op_sel_hi:[1,1,1]
    v_cvt_pk_bf16_f32 v48, v64, v65
    v_cvt_pk_bf16_f32 v49, v66, v67
    v_cvt_pk_bf16_f32 v50, v68, v69
    v_cvt_pk_bf16_f32 v51, v70, v71
    buffer_store_dwordx4 v[48:51], v1, s[24:27], s70 offen offset:0 sc1
    ds_read_b128 v[64:67], v26 offset:26672
    ds_read_b128 v[68:71], v26 offset:26672
    ds_read_b128 v[72:75], v26 offset:26672
    ds_read_b128 v[80:83], v26 offset:26672
    ds_read_b128 v[84:87], v26 offset:26672
    ds_read_b128 v[88:91], v26 offset:26672
    s_setprio 0
    s_waitcnt lgkmcnt(3)
    v_smfmac_f32_32x32x32_bf16 v[64:79], v[40:43], v[112:119], v25
    s_waitcnt lgkmcnt(0)
    v_smfmac_f32_32x32x32_bf16 v[80:95], v[44:47], v[120:127], v25
    s_setprio 2
    s_nop 10
    v_rcp_f32 v56, v73
    v_rcp_f32 v57, v89
    v_fma_f32 v58, v72, v56, s71
    v_fmac_f32 v58, v88, v57
    v_rcp_f32 v58, v58
    s_nop 0
    v_mul_f32 v58, v58, v60
    v_pk_mul_f32 v[56:57], v[56:57], v[58:59] op_sel_hi:[1,0]
    v_pk_mul_f32 v[64:65], v[64:65], v[56:57] op_sel_hi:[1,0]
    v_pk_mul_f32 v[66:67], v[66:67], v[56:57] op_sel_hi:[1,0]
    v_pk_mul_f32 v[68:69], v[68:69], v[56:57] op_sel_hi:[1,0]
    v_pk_mul_f32 v[70:71], v[70:71], v[56:57] op_sel_hi:[1,0]
    v_pk_fma_f32 v[64:65], v[80:81], v[56:57], v[64:65] op_sel:[0,1,0] op_sel_hi:[1,1,1]
    v_pk_fma_f32 v[66:67], v[82:83], v[56:57], v[66:67] op_sel:[0,1,0] op_sel_hi:[1,1,1]
    v_pk_fma_f32 v[68:69], v[84:85], v[56:57], v[68:69] op_sel:[0,1,0] op_sel_hi:[1,1,1]
    v_pk_fma_f32 v[70:71], v[86:87], v[56:57], v[70:71] op_sel:[0,1,0] op_sel_hi:[1,1,1]
    v_cvt_pk_bf16_f32 v52, v64, v65
    v_cvt_pk_bf16_f32 v53, v66, v67
    v_cvt_pk_bf16_f32 v54, v68, v69
    v_cvt_pk_bf16_f32 v55, v70, v71
    buffer_store_dwordx4 v[52:55], v1, s[24:27], s70 offen offset:1024 sc1
    buffer_load_dword v13, v8, s[24:27], s6 offen offset:12 sc1
    s_add_u32 s69, s79, 131072
    s_waitcnt vmcnt(1)
    s_mov_b64 exec, 1
    buffer_store_dword v21, v26, s[24:27], s69 offen offset:12
    s_mov_b64 exec, -1
    s_lshl_b32 s69, s58, 15
    s_add_u32 s70, s69, 98304
    v_add_u32 v18, s70, v20
    v_xor_b32 v19, 64, v18
    s_lshl_b32 s4, s58, 14
    s_add_u32 s4, s4, s88
    s_cmp_eq_u32 s78, 0
    s_cbranch_scc0 L_nf44
    s_mov_b32 s80, 4
    s_call_b64 s[92:93], L_fin
L_nf44:
L_sb45:
    ds_read_b32 v16, v26 offset:26624
    s_waitcnt lgkmcnt(0)
    v_readfirstlane_b32 s69, v16
    s_cmp_ge_u32 s69, 32
    s_cbranch_scc1 L_sbd46
    s_sub_u32 s68, s68, 1
    s_cbranch_scc1 L_sbd46_x
    s_sleep 1
    s_branch L_sb45
L_sbd46_x:
    s_mov_b32 s68, 0
L_sbd46:
    s_or_b32 s68, s68, 15
    s_mov_b32 s7, s6
L_po47:
    buffer_load_dword v16, v8, s[24:27], s7 offen offset:12 sc1
    s_waitcnt vmcnt(0)
    v_cmp_ne_u32 vcc, 1, v16
    s_cbranch_vccz L_pod48
    s_and_b32 s69, s68, 15
    s_cselect_b32 s7, s6, s87
    s_cbranch_scc1 L_po47n
    s_mov_b64 exec, 1
    buffer_store_dword v21, v26, s[24:27], s79 offen offset:12 sc1
    s_mov_b64 exec, -1
L_po47n:
    s_sub_u32 s68, s68, 1
    s_cbranch_scc1 L_pod48_x
    s_sleep 1
    s_branch L_po47
L_pod48_x:
    s_mov_b32 s68, 0
L_pod48:
    s_add_u32 s70, s4, 2097152
    buffer_load_dwordx4 a[0:3], v1, s[24:27], s70 offen offset:0 sc1
    buffer_load_dwordx4 a[4:7], v1, s[24:27], s70 offen offset:1024 sc1
    buffer_load_dwordx4 a[8:11], v1, s[24:27], s70 offen offset:2048 sc1
    buffer_load_dwordx4 a[12:15], v1, s[24:27], s70 offen offset:3072 sc1
    s_add_u32 s70, s70, 4096
    buffer_load_dwordx4 a[16:19], v1, s[24:27], s70 offen offset:0 sc1
    buffer_load_dwordx4 a[20:23], v1, s[24:27], s70 offen offset:1024 sc1
    buffer_load_dwordx4 a[24:27], v1, s[24:27], s70 offen offset:2048 sc1
    buffer_load_dwordx4 a[28:31], v1, s[24:27], s70 offen offset:3072 sc1
    s_add_u32 s70, s70, 4096
    buffer_load_dwordx4 a[32:35], v1, s[24:27], s70 offen offset:0 sc1
    buffer_load_dwordx4 a[36:39], v1, s[24:27], s70 offen offset:1024 sc1
    buffer_load_dwordx4 a[40:43], v1, s[24:27], s70 offen offset:2048 sc1
    buffer_load_dwordx4 a[44:47], v1, s[24:27], s70 offen offset:3072 sc1
    s_add_u32 s70, s70, 4096
    buffer_load_dwordx4 a[48:51], v1, s[24:27], s70 offen offset:0 sc1
    buffer_load_dwordx4 a[52:55], v1, s[24:27], s70 offen offset:1024 sc1
    buffer_load_dwordx4 a[56:59], v1, s[24:27], s70 offen offset:2048 sc1
    buffer_load_dwordx4 a[60:63], v1, s[24:27], s70 offen offset:3072 sc1
    s_cmp_eq_u32 s78, 1
    s_cbranch_scc0 L_nf49
    s_mov_b32 s80, 5
    s_call_b64 s[92:93], L_fin
L_nf49:
    s_cmp_le_u32 s78, 1
    s_cbranch_scc0 L_nf4
    buffer_store_dwordx4 v[84:87], v1, s[24:27], s89 offen sc1
L_nf4:
    s_setprio 0
    s_add_u32 s7, s88, 4194304
    ds_read_b64_tr_b16 v[32:33], v19 offset:0
    ds_read_b64_tr_b16 v[34:35], v19 offset:1024
    s_mov_b64 exec, 1
    buffer_store_dword v21, v26, s[24:27], s79 offen offset:12 sc1
    s_mov_b64 exec, -1
    s_waitcnt vmcnt(13)
    s_waitcnt lgkmcnt(0)
    v_mfma_f32_32x32x16_bf16 v[112:127], v[32:35], a[0:3], 0
    ds_read_b64_tr_b16 v[36:37], v19 offset:2048
    ds_read_b64_tr_b16 v[38:39], v19 offset:3072
    s_mul_i32 s69, s60, 65536
    s_add_u32 s69, s69, s55
    s_lshl_b32 s70, s60, 13
    s_add_u32 s70, s70, s59
    s_add_u32 m0, s70, 32768
    s_nop 0
    buffer_load_dwordx4 v4, s[36:39], s69 offen lds
    s_sub_u32 m0, m0, 4096
    s_nop 0
    buffer_load_dwordx4 v12, s[36:39], s69 offen lds
    s_waitcnt lgkmcnt(0)
    v_mfma_f32_32x32x16_bf16 v[112:127], v[36:39], a[4:7], v[112:127]
    ds_read_b64_tr_b16 v[40:41], v19 offset:4096
    ds_read_b64_tr_b16 v[42:43], v19 offset:5120
    s_mul_i32 s69, s61, 65536
    s_add_u32 s69, s69, s55
    s_lshl_b32 s70, s61, 13
    s_add_u32 s70, s70, s59
    s_add_u32 m0, s70, 32768
    s_nop 0
    buffer_load_dwordx4 v4, s[36:39], s69 offen lds
    s_sub_u32 m0, m0, 4096
    s_nop 0
    buffer_load_dwordx4 v12, s[36:39], s69 offen lds
    s_waitcnt lgkmcnt(0)
    v_mfma_f32_32x32x16_bf16 v[112:127], v[40:43], a[8:11], v[112:127]
    ds_read_b64_tr_b16 v[44:45], v19 offset:6144
    ds_read_b64_tr_b16 v[46:47], v19 offset:7168
    s_waitcnt lgkmcnt(0)
    v_mfma_f32_32x32x16_bf16 v[112:127], v[44:47], a[12:15], v[112:127]
    ds_read_b64_tr_b16 v[48:49], v19 offset:8192
    ds_read_b64_tr_b16 v[50:51], v19 offset:9216
    s_waitcnt vmcnt(13)
    s_waitcnt lgkmcnt(0)
    v_mfma_f32_32x32x16_bf16 v[112:127], v[48:51], a[16:19], v[112:127]
    ds_read_b64_tr_b16 v[32:33], v19 offset:10240
    ds_read_b64_tr_b16 v[34:35], v19 offset:11264
    s_add_u32 s70, s4, 0
    buffer_load_dwordx4 a[64:67], v1, s[24:27], s70 offen offset:0 sc1
    buffer_load_dwordx4 a[80:83], v1, s[24:27], s70 offen offset:1024 sc1
    s_waitcnt lgkmcnt(0)
    v_mfma_f32_32x32x16_bf16 v[112:127], v[32:35], a[20:23], v[112:127]
    ds_read_b64_tr_b16 v[36:37], v19 offset:12288
    ds_read_b64_tr_b16 v[38:39], v19 offset:13312
    s_add_u32 s70, s4, 4096
    buffer_load_dwordx4 a[68:71], v1, s[24:27], s70 offen offset:0 sc1
    buffer_load_dwordx4 a[84:87], v1, s[24:27], s70 offen offset:1024 sc1
    s_waitcnt lgkmcnt(0)
    v_mfma_f32_32x32x16_bf16 v[112:127], v[36:39], a[24:27], v[112:127]
    ds_read_b64_tr_b16 v[40:41], v19 offset:14336
    ds_read_b64_tr_b16 v[42:43], v19 offset:15360
    s_add_u32 s70, s4, 8192
    buffer_load_dwordx4 a[72:75], v1, s[24:27], s70 offen offset:0 sc1
    buffer_load_dwordx4 a[88:91], v1, s[24:27], s70 offen offset:1024 sc1
    s_waitcnt lgkmcnt(0)
    v_mfma_f32_32x32x16_bf16 v[112:127], v[40:43], a[28:31], v[112:127]
    ds_read_b64_tr_b16 v[44:45], v19 offset:16384
    ds_read_b64_tr_b16 v[46:47], v19 offset:17408
    s_add_u32 s70, s4, 12288
    buffer_load_dwordx4 a[76:79], v1, s[24:27], s70 offen offset:0 sc1
    buffer_load_dwordx4 a[92:95], v1, s[24:27], s70 offen offset:1024 sc1
    s_waitcnt vmcnt(17)
    s_waitcnt lgkmcnt(0)
    v_mfma_f32_32x32x16_bf16 v[112:127], v[44:47], a[32:35], v[112:127]
    ds_read_b64_tr_b16 v[48:49], v19 offset:18432
    ds_read_b64_tr_b16 v[50:51], v19 offset:19456
    s_waitcnt lgkmcnt(0)
    v_mfma_f32_32x32x16_bf16 v[112:127], v[48:51], a[36:39], v[112:127]
    ds_read_b64_tr_b16 v[32:33], v19 offset:20480
    ds_read_b64_tr_b16 v[34:35], v19 offset:21504
    s_waitcnt lgkmcnt(0)
    v_mfma_f32_32x32x16_bf16 v[112:127], v[32:35], a[40:43], v[112:127]
    ds_read_b64_tr_b16 v[36:37], v19 offset:22528
    ds_read_b64_tr_b16 v[38:39], v19 offset:23552
    s_waitcnt lgkmcnt(0)
    v_mfma_f32_32x32x16_bf16 v[112:127], v[36:39], a[44:47], v[112:127]
    ds_read_b64_tr_b16 v[40:41], v19 offset:24576
    ds_read_b64_tr_b16 v[42:43], v19 offset:25600
    s_waitcnt vmcnt(13)
    s_mul_i32 s69, s62, 65536
    s_add_u32 s69, s69, s55
    s_lshl_b32 s70, s62, 13
    s_add_u32 s70, s70, s59
    s_add_u32 m0, s70, 32768
    s_nop 0
    buffer_load_dwordx4 v4, s[36:39], s69 offen lds
    s_sub_u32 m0, m0, 4096
    s_nop 0
    buffer_load_dwordx4 v12, s[36:39], s69 offen lds
    s_waitcnt lgkmcnt(0)
    v_mfma_f32_32x32x16_bf16 v[112:127], v[40:43], a[48:51], v[112:127]
    ds_read_b64_tr_b16 v[44:45], v19 offset:26624
    ds_read_b64_tr_b16 v[46:47], v19 offset:27648
    s_cmp_eq_u32 s78, 3
    s_cbranch_scc0 L_nopt
    s_add_u32 s6, s7, 0
    buffer_load_dwordx4 a[96:99], v1, s[24:27], s6 offen offset:3072 sc1
    s_add_u32 s6, s7, 4096
    buffer_load_dwordx4 a[96:99], v1, s[24:27], s6 offen offset:3072 sc1
    s_add_u32 s6, s7, 8192
    buffer_load_dwordx4 a[96:99], v1, s[24:27], s6 offen offset:3072 sc1
    s_add_u32 s6, s7, 12288
    buffer_load_dwordx4 a[96:99], v1, s[24:27], s6 offen offset:3072 sc1
    s_add_u32 s6, s7, 16384
    buffer_load_dwordx4 a[96:99], v1, s[24:27], s6 offen offset:3072 sc1
    s_add_u32 s6, s7, 20480
L_pg6:
    s_cbranch_execz L_wret
    buffer_load_dwordx4 a[96:99], v1, s[24:27], s6 offen offset:3072 sc1
    s_add_u32 s6, s7, 24576
    buffer_load_dwordx4 a[96:99], v1, s[24:27], s6 offen offset:3072 sc1
    s_add_u32 s6, s7, 28672
    buffer_load_dwordx4 a[96:99], v1, s[24:27], s6 offen offset:3072 sc1
L_nopt:
    s_waitcnt lgkmcnt(0)
    v_mfma_f32_32x32x16_bf16 v[112:127], v[44:47], a[52:55], v[112:127]
    ds_read_b64_tr_b16 v[48:49], v19 offset:28672
    ds_read_b64_tr_b16 v[50:51], v19 offset:29696
    s_mul_i32 s69, s63, 65536
    s_add_u32 s69, s69, s55
    s_lshl_b32 s70, s63, 13
    s_add_u32 s70, s70, s59
    s_add_u32 m0, s70, 32768
    s_nop 0
    buffer_load_dwordx4 v4, s[36:39], s69 offen lds
    s_sub_u32 m0, m0, 4096
    s_nop 0
    buffer_load_dwordx4 v12, s[36:39], s69 offen lds
    s_waitcnt lgkmcnt(0)
    v_mfma_f32_32x32x16_bf16 v[112:127], v[48:51], a[56:59], v[112:127]
    ds_read_b64_tr_b16 v[32:33], v19 offset:30720
    ds_read_b64_tr_b16 v[34:35], v19 offset:31744
    s_waitcnt lgkmcnt(0)
    v_mfma_f32_32x32x16_bf16 v[112:127], v[32:35], a[60:63], v[112:127]
    ds_read_b64_tr_b16 v[36:37], v18 offset:0
    ds_read_b64_tr_b16 v[38:39], v18 offset:1024
    s_mul_i32 s69, s64, 65536
    s_add_u32 s69, s69, s55
    s_lshl_b32 s70, s64, 13
    s_add_u32 s70, s70, s59
    s_add_u32 m0, s70, 32768
    s_nop 0
    buffer_load_dwordx4 v4, s[36:39], s69 offen lds
    s_sub_u32 m0, m0, 4096
    s_nop 0
    buffer_load_dwordx4 v12, s[36:39], s69 offen lds
    s_waitcnt lgkmcnt(0)
    v_mfma_f32_32x32x16_bf16 v[96:111], v[36:39], a[0:3], 0
    ds_read_b64_tr_b16 v[40:41], v18 offset:2048
    ds_read_b64_tr_b16 v[42:43], v18 offset:3072
    s_waitcnt lgkmcnt(0)
    v_mfma_f32_32x32x16_bf16 v[96:111], v[40:43], a[4:7], v[96:111]
    ds_read_b64_tr_b16 v[44:45], v18 offset:4096
    ds_read_b64_tr_b16 v[46:47], v18 offset:5120
    s_mul_i32 s69, s65, 65536
    s_add_u32 s69, s69, s55
    s_lshl_b32 s70, s65, 13
    s_add_u32 s70, s70, s59
    s_add_u32 m0, s70, 32768
    s_nop 0
    buffer_load_dwordx4 v4, s[36:39], s69 offen lds
    s_sub_u32 m0, m0, 4096
    s_nop 0
    buffer_load_dwordx4 v12, s[36:39], s69 offen lds
    s_waitcnt lgkmcnt(0)
    v_mfma_f32_32x32x16_bf16 v[96:111], v[44:47], a[8:11], v[96:111]
    ds_read_b64_tr_b16 v[48:49], v18 offset:6144
    ds_read_b64_tr_b16 v[50:51], v18 offset:7168
    s_waitcnt lgkmcnt(0)
    v_mfma_f32_32x32x16_bf16 v[96:111], v[48:51], a[12:15], v[96:111]
    ds_read_b64_tr_b16 v[32:33], v18 offset:8192
    ds_read_b64_tr_b16 v[34:35], v18 offset:9216
    s_mul_i32 s69, s66, 65536
    s_add_u32 s69, s69, s55
    s_lshl_b32 s70, s66, 13
    s_add_u32 s70, s70, s59
    s_add_u32 m0, s70, 32768
    s_nop 0
    buffer_load_dwordx4 v4, s[36:39], s69 offen lds
    s_sub_u32 m0, m0, 4096
    s_nop 0
    buffer_load_dwordx4 v12, s[36:39], s69 offen lds
    s_waitcnt lgkmcnt(0)
    v_mfma_f32_32x32x16_bf16 v[96:111], v[32:35], a[16:19], v[96:111]
    ds_read_b64_tr_b16 v[36:37], v18 offset:10240
    ds_read_b64_tr_b16 v[38:39], v18 offset:11264
    s_waitcnt lgkmcnt(0)
    v_mfma_f32_32x32x16_bf16 v[96:111], v[36:39], a[20:23], v[96:111]
    ds_read_b64_tr_b16 v[40:41], v18 offset:12288
    ds_read_b64_tr_b16 v[42:43], v18 offset:13312
    s_mul_i32 s69, s67, 65536
    s_add_u32 s69, s69, s55
    s_lshl_b32 s70, s67, 13
    s_add_u32 s70, s70, s59
    s_add_u32 m0, s70, 32768
    s_nop 0
    buffer_load_dwordx4 v4, s[36:39], s69 offen lds
    s_sub_u32 m0, m0, 4096
    s_nop 0
    buffer_load_dwordx4 v12, s[36:39], s69 offen lds
    s_waitcnt lgkmcnt(0)
    v_mfma_f32_32x32x16_bf16 v[96:111], v[40:43], a[24:27], v[96:111]
    ds_read_b64_tr_b16 v[44:45], v18 offset:14336
    ds_read_b64_tr_b16 v[46:47], v18 offset:15360
    s_waitcnt lgkmcnt(0)
    v_mfma_f32_32x32x16_bf16 v[96:111], v[44:47], a[28:31], v[96:111]
    ds_read_b64_tr_b16 v[48:49], v18 offset:16384
    ds_read_b64_tr_b16 v[50:51], v18 offset:17408
    s_mov_b32 s70, s4
    buffer_load_dwordx4 v[64:67], v1, s[24:27], s70 offen offset:2048 sc1
    s_add_u32 s70, s70, 4096
    buffer_load_dwordx4 v[68:71], v1, s[24:27], s70 offen offset:2048 sc1
    s_add_u32 s70, s70, 4096
    buffer_load_dwordx4 v[72:75], v1, s[24:27], s70 offen offset:2048 sc1
    s_add_u32 s70, s70, 4096
    buffer_load_dwordx4 v[76:79], v1, s[24:27], s70 offen offset:2048 sc1
    s_waitcnt lgkmcnt(0)
    v_mfma_f32_32x32x16_bf16 v[96:111], v[48:51], a[32:35], v[96:111]
    ds_read_b64_tr_b16 v[32:33], v18 offset:18432
    ds_read_b64_tr_b16 v[34:35], v18 offset:19456
    s_waitcnt lgkmcnt(0)
    v_mfma_f32_32x32x16_bf16 v[96:111], v[32:35], a[36:39], v[96:111]
    ds_read_b64_tr_b16 v[36:37], v18 offset:20480
    ds_read_b64_tr_b16 v[38:39], v18 offset:21504
    s_waitcnt lgkmcnt(0)
    v_mfma_f32_32x32x16_bf16 v[96:111], v[36:39], a[40:43], v[96:111]
    ds_read_b64_tr_b16 v[40:41], v18 offset:22528
    ds_read_b64_tr_b16 v[42:43], v18 offset:23552
    s_waitcnt lgkmcnt(0)
    v_mfma_f32_32x32x16_bf16 v[96:111], v[40:43], a[44:47], v[96:111]
    ds_read_b64_tr_b16 v[44:45], v18 offset:24576
    ds_read_b64_tr_b16 v[46:47], v18 offset:25600
    s_waitcnt vmcnt(4)
    s_mov_b64 exec, 1
    ds_add_u32 v26, v21 offset:26624
    s_mov_b64 exec, -1
    s_waitcnt lgkmcnt(0)
    v_mfma_f32_32x32x16_bf16 v[96:111], v[44:47], a[48:51], v[96:111]
    ds_read_b64_tr_b16 v[48:49], v18 offset:26624
    ds_read_b64_tr_b16 v[50:51], v18 offset:27648
    s_waitcnt lgkmcnt(0)
    v_mfma_f32_32x32x16_bf16 v[96:111], v[48:51], a[52:55], v[96:111]
    ds_read_b64_tr_b16 v[32:33], v18 offset:28672
    ds_read_b64_tr_b16 v[34:35], v18 offset:29696
    s_waitcnt lgkmcnt(0)
    v_mfma_f32_32x32x16_bf16 v[96:111], v[32:35], a[56:59], v[96:111]
    ds_read_b64_tr_b16 v[36:37], v18 offset:30720
    ds_read_b64_tr_b16 v[38:39], v18 offset:31744
    s_waitcnt lgkmcnt(0)
    v_mfma_f32_32x32x16_bf16 v[96:111], v[36:39], a[60:63], v[96:111]
    s_setprio 2
    s_branch L_a250c
L_a250:
    s_mov_b32 s70, s4
    buffer_load_dwordx4 v[64:67], v1, s[24:27], s70 offen offset:2048 sc1
    s_add_u32 s70, s70, 4096
    buffer_load_dwordx4 v[68:71], v1, s[24:27], s70 offen offset:2048 sc1
    s_add_u32 s70, s70, 4096
    buffer_load_dwordx4 v[72:75], v1, s[24:27], s70 offen offset:2048 sc1
    s_add_u32 s70, s70, 4096
    buffer_load_dwordx4 v[76:79], v1, s[24:27], s70 offen offset:2048 sc1
L_a250c:
    s_waitcnt vmcnt(0)
    v_max3_u32 v16, v64, v65, v66
    v_max3_u32 v16, v16, v67, v68
    v_max3_u32 v16, v16, v69, v70
    v_max3_u32 v16, v16, v71, v72
    v_max3_u32 v16, v16, v73, v74
    v_max3_u32 v16, v16, v75, v76
    v_max3_u32 v16, v16, v77, v78
    v_max_u32 v16, v16, v79
    v_cmp_eq_u32 vcc, -1, v16
    s_cbranch_vccz L_a2d51
    s_sub_u32 s68, s68, 1
    s_cbranch_scc1 L_a2d51_x
    s_sleep 6
    s_branch L_a250
L_a2d51_x:
    s_mov_b32 s68, 0
L_a2d51:
    s_mov_b32 s70, s4
    buffer_load_dwordx4 a[0:3], v1, s[24:27], s70 offen offset:2048 sc1
    s_add_u32 s70, s70, 4096
    buffer_load_dwordx4 a[4:7], v1, s[24:27], s70 offen offset:2048 sc1
    s_add_u32 s70, s70, 4096
    buffer_load_dwordx4 a[8:11], v1, s[24:27], s70 offen offset:2048 sc1
    s_add_u32 s70, s70, 4096
    buffer_load_dwordx4 a[12:15], v1, s[24:27], s70 offen offset:2048 sc1
    buffer_load_dword v13, v26, s[24:27], s4 offen sc1
    buffer_load_dword v13, v26, s[24:27], s4 offen sc1
    s_cmp_eq_u32 s78, 2
    s_cbranch_scc0 L_f652
    s_mov_b32 s80, 6
    s_call_b64 s[92:93], L_fin
    buffer_store_dwordx4 v[84:87], v1, s[24:27], s89 offen sc1
    s_add_u32 s89, s89, 4194304
    buffer_store_dwordx4 v[84:87], v1, s[24:27], s89 offen
L_f652:
    s_lshl_b32 s69, s58, 15
    s_add_u32 s70, s69, 32768
    v_add_u32 v3, s70, v20
    v_xor_b32 v7, 64, v3
    s_sub_u32 s5, s88, 4194304
    s_add_u32 s5, s5, s55
    s_lshl_b32 s72, s58, 6
    s_add_u32 s5, s5, s72
    s_lshl_b32 s71, s78, 12
    s_add_u32 s71, s71, 98304
    s_xor_b32 s72, s71, 0x2000
L_sb53:
    ds_read_b32 v16, v26 offset:26624
    s_waitcnt lgkmcnt(0)
    v_readfirstlane_b32 s69, v16
    s_cmp_ge_u32 s69, 36
    s_cbranch_scc1 L_sbd54
    s_sub_u32 s68, s68, 1
    s_cbranch_scc1 L_sbd54_x
    s_sleep 1
    s_branch L_sb53
L_sbd54_x:
    s_mov_b32 s68, 0
L_sbd54:
    v_add_u32 v20, 32768, v20
    ds_read_b64_tr_b16 a[96:97], v20 offset:6144
    ds_read_b64_tr_b16 a[98:99], v20 offset:7168
    ds_read_b64_tr_b16 a[100:101], v20 offset:14336
    ds_read_b64_tr_b16 a[102:103], v20 offset:15360
    ds_read_b64_tr_b16 a[104:105], v20 offset:22528
    ds_read_b64_tr_b16 a[106:107], v20 offset:23552
    ds_read_b64_tr_b16 a[108:109], v20 offset:30720
    ds_read_b64_tr_b16 a[110:111], v20 offset:31744
    ds_read_b64_tr_b16 a[112:113], v20 offset:38912
    ds_read_b64_tr_b16 a[114:115], v20 offset:39936
    ds_read_b64_tr_b16 a[116:117], v20 offset:47104
    ds_read_b64_tr_b16 a[118:119], v20 offset:48128
    ds_read_b64_tr_b16 a[120:121], v20 offset:55296
    ds_read_b64_tr_b16 a[122:123], v20 offset:56320
    ds_read_b64_tr_b16 a[124:125], v20 offset:63488
    ds_read_b64_tr_b16 a[126:127], v20 offset:64512
    v_add_u32 v23, s71, v1
    v_add_u32 v24, s72, v1
    s_waitcnt vmcnt(2)
    ds_read_b64_tr_b16 v[32:33], v7 offset:4096
    ds_read_b64_tr_b16 v[34:35], v7 offset:5120
    ds_read_b64_tr_b16 v[36:37], v7 offset:12288
    ds_read_b64_tr_b16 v[38:39], v7 offset:13312
    ds_read_b64_tr_b16 v[40:41], v7 offset:20480
    ds_read_b64_tr_b16 v[42:43], v7 offset:21504
    ds_read_b64_tr_b16 v[44:45], v7 offset:28672
    ds_read_b64_tr_b16 v[46:47], v7 offset:29696
    s_barrier
    ds_read_b64_tr_b16 v[48:49], v7 offset:0
    ds_read_b64_tr_b16 v[50:51], v7 offset:1024
    s_waitcnt lgkmcnt(8)
    v_mfma_f32_32x32x16_bf16 v[112:127], v[32:35], a[0:3], v[112:127]
    s_cmp_eq_u32 s57, 0
    s_cbranch_scc0 L_li55
    s_add_u32 s6, s7, 0
    buffer_load_dwordx4 v[80:83], v1, s[24:27], s6 offen offset:3072 sc1
    s_add_u32 s6, s7, 4096
    buffer_load_dwordx4 v[84:87], v1, s[24:27], s6 offen offset:3072 sc1
    s_add_u32 s6, s7, 8192
    buffer_load_dwordx4 v[88:91], v1, s[24:27], s6 offen offset:3072 sc1
    s_add_u32 s6, s7, 12288
    buffer_load_dwordx4 v[92:95], v1, s[24:27], s6 offen offset:3072 sc1
    s_add_u32 s6, s7, 16384
    buffer_load_dwordx4 v[64:67], v1, s[24:27], s6 offen offset:3072 sc1
    s_add_u32 s6, s7, 20480
    buffer_load_dwordx4 v[68:71], v1, s[24:27], s6 offen offset:3072 sc1
    s_add_u32 s6, s7, 24576
    buffer_load_dwordx4 v[72:75], v1, s[24:27], s6 offen offset:3072 sc1
    s_add_u32 s6, s7, 28672
    buffer_load_dwordx4 v[76:79], v1, s[24:27], s6 offen offset:3072 sc1
L_li55:
    ds_read_b64_tr_b16 v[32:33], v7 offset:8192
    ds_read_b64_tr_b16 v[34:35], v7 offset:9216
    s_waitcnt lgkmcnt(8)
    v_mfma_f32_32x32x16_bf16 v[112:127], v[36:39], a[4:7], v[112:127]
    ds_read_b64_tr_b16 v[36:37], v7 offset:16384
    ds_read_b64_tr_b16 v[38:39], v7 offset:17408
    s_waitcnt lgkmcnt(8)
    v_mfma_f32_32x32x16_bf16 v[112:127], v[40:43], a[8:11], v[112:127]
    v_and_b32 v17, 0x1f0, v1
    v_lshlrev_b32 v17, 6, v17
    ds_read_b64_tr_b16 v[40:41], v7 offset:24576
    ds_read_b64_tr_b16 v[42:43], v7 offset:25600
    s_waitcnt lgkmcnt(8)
    v_mfma_f32_32x32x16_bf16 v[112:127], v[44:47], a[12:15], v[112:127]
    v_lshrrev_b32 v16, 9, v1
    v_lshl_add_u32 v28, v16, 5, v17
    ds_read_b64_tr_b16 v[44:45], v7 offset:2048
    ds_read_b64_tr_b16 v[46:47], v7 offset:3072
    s_waitcnt lgkmcnt(8)
    v_mfma_f32_32x32x16_bf16 v[112:127], v[48:51], a[64:67], v[112:127]
    ds_read_b64_tr_b16 v[48:49], v7 offset:10240
    ds_read_b64_tr_b16 v[50:51], v7 offset:11264
    s_waitcnt lgkmcnt(8)
    v_mfma_f32_32x32x16_bf16 v[112:127], v[32:35], a[68:71], v[112:127]
    ds_read_b64_tr_b16 v[32:33], v7 offset:18432
    ds_read_b64_tr_b16 v[34:35], v7 offset:19456
    s_waitcnt lgkmcnt(8)
    v_mfma_f32_32x32x16_bf16 v[112:127], v[36:39], a[72:75], v[112:127]
    ds_read_b64_tr_b16 v[36:37], v7 offset:26624
    ds_read_b64_tr_b16 v[38:39], v7 offset:27648
    s_waitcnt lgkmcnt(8)
    v_mfma_f32_32x32x16_bf16 v[112:127], v[40:43], a[76:79], v[112:127]
    ds_read_b64_tr_b16 v[40:41], v3 offset:4096
    ds_read_b64_tr_b16 v[42:43], v3 offset:5120
    s_waitcnt lgkmcnt(8)
    v_mfma_f32_32x32x16_bf16 v[112:127], v[44:47], a[80:83], v[112:127]
    ds_read_b64_tr_b16 v[44:45], v3 offset:12288
    ds_read_b64_tr_b16 v[46:47], v3 offset:13312
    s_waitcnt lgkmcnt(8)
    v_mfma_f32_32x32x16_bf16 v[112:127], v[48:51], a[84:87], v[112:127]
    ds_read_b64_tr_b16 v[48:49], v3 offset:20480
    ds_read_b64_tr_b16 v[50:51], v3 offset:21504
    s_waitcnt lgkmcnt(8)
    v_mfma_f32_32x32x16_bf16 v[112:127], v[32:35], a[88:91], v[112:127]
    ds_read_b64_tr_b16 v[32:33], v3 offset:28672
    ds_read_b64_tr_b16 v[34:35], v3 offset:29696
    s_waitcnt lgkmcnt(8)
    v_mfma_f32_32x32x16_bf16 v[112:127], v[36:39], a[92:95], v[112:127]
    ds_read_b64_tr_b16 v[36:37], v3 offset:0
    ds_read_b64_tr_b16 v[38:39], v3 offset:1024
    s_waitcnt lgkmcnt(8)
    v_mfma_f32_32x32x16_bf16 v[96:111], v[40:43], a[0:3], v[96:111]
    ds_read_b64_tr_b16 v[40:41], v3 offset:8192
    ds_read_b64_tr_b16 v[42:43], v3 offset:9216
    s_waitcnt lgkmcnt(8)
    v_mfma_f32_32x32x16_bf16 v[96:111], v[44:47], a[4:7], v[96:111]
    ds_read_b64_tr_b16 v[44:45], v3 offset:16384
    ds_read_b64_tr_b16 v[46:47], v3 offset:17408
    s_waitcnt lgkmcnt(8)
    v_mfma_f32_32x32x16_bf16 v[96:111], v[48:51], a[8:11], v[96:111]
    ds_write_b128 v23, v[112:115] offset:0
    ds_read_b64_tr_b16 v[48:49], v3 offset:24576
    ds_read_b64_tr_b16 v[50:51], v3 offset:25600
    s_waitcnt lgkmcnt(8)
    v_mfma_f32_32x32x16_bf16 v[96:111], v[32:35], a[12:15], v[96:111]
    ds_write_b128 v23, v[116:119] offset:1024
    ds_read_b64_tr_b16 v[32:33], v3 offset:2048
    ds_read_b64_tr_b16 v[34:35], v3 offset:3072
    s_waitcnt lgkmcnt(8)
    v_mfma_f32_32x32x16_bf16 v[96:111], v[36:39], a[64:67], v[96:111]
    ds_write_b128 v23, v[120:123] offset:2048
    ds_read_b64_tr_b16 v[36:37], v3 offset:10240
    ds_read_b64_tr_b16 v[38:39], v3 offset:11264
    s_waitcnt lgkmcnt(8)
    v_mfma_f32_32x32x16_bf16 v[96:111], v[40:43], a[68:71], v[96:111]
    ds_write_b128 v23, v[124:127] offset:3072
    s_cmp_eq_u32 s57, 1
    s_cbranch_scc0 L_li56
    s_add_u32 s6, s7, 0
    buffer_load_dwordx4 v[80:83], v1, s[24:27], s6 offen offset:3072 sc1
    s_add_u32 s6, s7, 4096
    buffer_load_dwordx4 v[84:87], v1, s[24:27], s6 offen offset:3072 sc1
    s_add_u32 s6, s7, 8192
    buffer_load_dwordx4 v[88:91], v1, s[24:27], s6 offen offset:3072 sc1
    s_add_u32 s6, s7, 12288
    buffer_load_dwordx4 v[92:95], v1, s[24:27], s6 offen offset:3072 sc1
    s_add_u32 s6, s7, 16384
    buffer_load_dwordx4 v[64:67], v1, s[24:27], s6 offen offset:3072 sc1
    s_add_u32 s6, s7, 20480
    buffer_load_dwordx4 v[68:71], v1, s[24:27], s6 offen offset:3072 sc1
    s_add_u32 s6, s7, 24576
    buffer_load_dwordx4 v[72:75], v1, s[24:27], s6 offen offset:3072 sc1
    s_add_u32 s6, s7, 28672
    buffer_load_dwordx4 v[76:79], v1, s[24:27], s6 offen offset:3072 sc1
L_li56:
    ds_read_b64_tr_b16 v[40:41], v3 offset:18432
    ds_read_b64_tr_b16 v[42:43], v3 offset:19456
    s_waitcnt lgkmcnt(8)
    v_mfma_f32_32x32x16_bf16 v[96:111], v[44:47], a[72:75], v[96:111]
    ds_read_b64_tr_b16 v[44:45], v3 offset:26624
    ds_read_b64_tr_b16 v[46:47], v3 offset:27648
    s_waitcnt lgkmcnt(8)
    v_mfma_f32_32x32x16_bf16 v[96:111], v[48:51], a[76:79], v[96:111]
    s_waitcnt lgkmcnt(6)
    v_mfma_f32_32x32x16_bf16 v[96:111], v[32:35], a[80:83], v[96:111]
    s_waitcnt lgkmcnt(4)
    v_mfma_f32_32x32x16_bf16 v[96:111], v[36:39], a[84:87], v[96:111]
    s_waitcnt lgkmcnt(2)
    v_mfma_f32_32x32x16_bf16 v[96:111], v[40:43], a[88:91], v[96:111]
    s_waitcnt lgkmcnt(0)
    v_mfma_f32_32x32x16_bf16 v[96:111], v[44:47], a[92:95], v[96:111]
    s_barrier
    ds_read_b128 v[112:115], v24 offset:0
    ds_read_b128 v[116:119], v24 offset:1024
    ds_read_b128 v[120:123], v24 offset:2048
    ds_read_b128 v[124:127], v24 offset:3072
    s_mov_b32 s4, s7
    s_or_b32 s68, s68, 7
L_lt57c:
    s_waitcnt vmcnt(7)
    v_max3_u32 v16, v80, v81, v82
    v_max_u32 v16, v16, v83
    s_waitcnt vmcnt(6)
    v_max3_u32 v16, v16, v84, v85
    v_max3_u32 v16, v16, v86, v87
    s_waitcnt vmcnt(5)
    v_max3_u32 v16, v16, v88, v89
    v_max3_u32 v16, v16, v90, v91
    s_waitcnt vmcnt(4)
    v_max3_u32 v16, v16, v92, v93
    v_max3_u32 v16, v16, v94, v95
    s_waitcnt vmcnt(3)
    v_max3_u32 v16, v16, v64, v65
    v_max3_u32 v16, v16, v66, v67
    s_waitcnt vmcnt(2)
    v_max3_u32 v16, v16, v68, v69
    v_max3_u32 v16, v16, v70, v71
    s_waitcnt vmcnt(1)
    v_max3_u32 v16, v16, v72, v73
    v_max3_u32 v16, v16, v74, v75
    s_waitcnt vmcnt(0)
    v_max3_u32 v16, v16, v76, v77
    v_max3_u32 v16, v16, v78, v79
    v_cmp_eq_u32 vcc, -1, v16
    s_cbranch_vccnz L_lt57
L_ltd58:
    v_mfma_f32_32x32x16_bf16 v[96:111], a[96:99], v[80:83], v[96:111]
    v_lshrrev_b32 v16, 10, v28
    v_mul_u32_u24 v16, 80, v16
    v_and_b32 v17, 32, v28
    v_mfma_f32_32x32x16_bf16 v[96:111], a[100:103], v[84:87], v[96:111]
    s_mul_i32 s69, s78, 2560
    s_add_u32 s69, s69, 114688
    v_add3_u32 v44, v16, v17, s69
    v_mfma_f32_32x32x16_bf16 v[96:111], a[104:107], v[88:91], v[96:111]
    v_lshrrev_b32 v16, 6, v1
    v_and_b32 v17, 48, v1
    v_lshl_add_u32 v46, v16, 10, v17
    v_mfma_f32_32x32x16_bf16 v[96:111], a[108:111], v[92:95], v[96:111]
    v_mul_u32_u24 v16, 80, v16
    v_add3_u32 v45, v16, v17, s69
    v_mfma_f32_32x32x16_bf16 v[96:111], a[112:115], v[64:67], v[96:111]
    v_mfma_f32_32x32x16_bf16 v[96:111], a[116:119], v[68:71], v[96:111]
    v_mfma_f32_32x32x16_bf16 v[96:111], a[120:123], v[72:75], v[96:111]
    v_mfma_f32_32x32x16_bf16 v[96:111], a[124:127], v[76:79], v[96:111]
    s_waitcnt lgkmcnt(0)
    s_nop 10
    v_pk_add_f32 v[96:97], v[96:97], v[112:113]
    v_pk_add_f32 v[98:99], v[98:99], v[114:115]
    v_pk_add_f32 v[100:101], v[100:101], v[116:117]
    v_pk_add_f32 v[102:103], v[102:103], v[118:119]
    v_pk_add_f32 v[104:105], v[104:105], v[120:121]
    v_pk_add_f32 v[106:107], v[106:107], v[122:123]
    v_pk_add_f32 v[108:109], v[108:109], v[124:125]
    v_pk_add_f32 v[110:111], v[110:111], v[126:127]
    v_cvt_pk_bf16_f32 v36, v96, v97
    v_cvt_pk_bf16_f32 v37, v98, v99
    v_cvt_pk_bf16_f32 v38, v100, v101
    v_cvt_pk_bf16_f32 v39, v102, v103
    v_cvt_pk_bf16_f32 v40, v104, v105
    v_cvt_pk_bf16_f32 v41, v106, v107
    v_cvt_pk_bf16_f32 v42, v108, v109
    v_cvt_pk_bf16_f32 v43, v110, v111
    ds_write_b128 v44, v[36:39]
    ds_write_b128 v44, v[40:43] offset:16
    ds_read_b128 v[36:39], v45
    ds_read_b128 v[40:43], v45 offset:1280
    s_waitcnt lgkmcnt(1)
    buffer_store_dwordx4 v[36:39], v46, s[44:47], s5 offen nt
    s_add_u32 s5, s5, 16384
    s_waitcnt lgkmcnt(0)
    buffer_store_dwordx4 v[40:43], v46, s[44:47], s5 offen nt
L_exit:
    s_endpgm
L_lt57:
    s_sub_u32 s68, s68, 1
    s_cbranch_scc1 L_lt57x
    s_and_b32 s6, s68, 7
    s_cselect_b32 s7, s4, s88
    s_add_u32 s6, s7, 0
    buffer_load_dwordx4 v[80:83], v1, s[24:27], s6 offen offset:3072 sc1
    s_add_u32 s6, s7, 4096
    buffer_load_dwordx4 v[84:87], v1, s[24:27], s6 offen offset:3072 sc1
    s_add_u32 s6, s7, 8192
    buffer_load_dwordx4 v[88:91], v1, s[24:27], s6 offen offset:3072 sc1
    s_add_u32 s6, s7, 12288
    buffer_load_dwordx4 v[92:95], v1, s[24:27], s6 offen offset:3072 sc1
    s_add_u32 s6, s7, 16384
    buffer_load_dwordx4 v[64:67], v1, s[24:27], s6 offen offset:3072 sc1
    s_add_u32 s6, s7, 20480
    buffer_load_dwordx4 v[68:71], v1, s[24:27], s6 offen offset:3072 sc1
    s_add_u32 s6, s7, 24576
    buffer_load_dwordx4 v[72:75], v1, s[24:27], s6 offen offset:3072 sc1
    s_add_u32 s6, s7, 28672
    buffer_load_dwordx4 v[76:79], v1, s[24:27], s6 offen offset:3072 sc1
    s_branch L_lt57c
L_lt57x:
    s_mov_b32 s68, 0
    s_branch L_ltd58
L_pg0:
    s_cbranch_execz L_wret
L_fin:
    ds_read_b32 v17, v2 offset:26632
    ds_read2st64_b32 v[80:81], v15 offset0:8 offset1:17
    ds_read2st64_b32 v[82:83], v15 offset0:26 offset1:35
    ds_read2st64_b32 v[32:33], v14 offset0:0 offset1:1
    ds_read2st64_b32 v[34:35], v14 offset0:2 offset1:3
    ds_read2st64_b32 v[36:37], v14 offset0:4 offset1:5
    ds_read2st64_b32 v[38:39], v14 offset0:6 offset1:7
    ds_read2st64_b32 v[40:41], v14 offset0:9 offset1:10
    ds_read2st64_b32 v[42:43], v14 offset0:11 offset1:12
    ds_read2st64_b32 v[44:45], v14 offset0:13 offset1:14
    ds_read2st64_b32 v[46:47], v14 offset0:15 offset1:16
    ds_read2st64_b32 v[48:49], v14 offset0:18 offset1:19
    ds_read2st64_b32 v[50:51], v14 offset0:20 offset1:21
    ds_read2st64_b32 v[52:53], v14 offset0:22 offset1:23
    ds_read2st64_b32 v[54:55], v14 offset0:24 offset1:25
    ds_read2st64_b32 v[56:57], v14 offset0:27 offset1:28
    ds_read2st64_b32 v[58:59], v14 offset0:29 offset1:30
    ds_read2st64_b32 v[60:61], v14 offset0:31 offset1:32
    ds_read2st64_b32 v[62:63], v14 offset0:33 offset1:34
    s_lshr_b32 s70, s80, 1
    s_waitcnt lgkmcnt(15)
    v_min3_f32 v16, v80, v81, v82
    v_cmp_ne_u32 s[82:83], s70, v17
    v_min_f32 v16, v16, v83
    v_cmp_eq_f32 vcc, -1.0, v16
    s_or_b64 vcc, vcc, s[82:83]
    s_cbranch_vccz L_fpd59
    v_lshrrev_b32 v16, 8, v1
    v_mul_u32_u24 v16, 2304, v16
    v_add_u32 v16, v16, v15
L_finw:
    s_sub_u32 s68, s68, 1
    s_cbranch_scc1 L_fpd59_x
    s_sleep 3
    ds_read_b32 v17, v16 offset:2048
    s_waitcnt lgkmcnt(0)
    v_cmp_eq_f32 vcc, -1.0, v17
    s_cbranch_vccnz L_finw
    s_branch L_fin
L_fpd59_x:
    s_mov_b32 s68, 0
L_fpd59:
    v_pk_add_f32 v[80:81], v[80:81], v[82:83]
    s_lshl_b32 s70, s70, 10
    s_add_u32 s89, s70, s81
    v_add_f32 v81, v80, v81
    s_mov_b32 s82, 1635778560
    s_mov_b32 s83, 1602224128
    v_rcp_f32 v80, v81
    s_waitcnt lgkmcnt(0)
    ds_write2st64_b32 v14, v22, v22 offset0:8 offset1:17
    ds_write2st64_b32 v14, v22, v22 offset0:26 offset1:35
    s_mov_b64 exec, 1
    ds_add_u32 v2, v21 offset:26632
    s_mov_b64 exec, -1
    v_pk_add_f32 v[32:33], v[32:33], v[40:41]
    v_pk_add_f32 v[34:35], v[34:35], v[42:43]
    v_pk_add_f32 v[36:37], v[36:37], v[44:45]
    v_pk_add_f32 v[38:39], v[38:39], v[46:47]
    v_pk_add_f32 v[48:49], v[48:49], v[56:57]
    v_pk_add_f32 v[50:51], v[50:51], v[58:59]
    v_pk_add_f32 v[52:53], v[52:53], v[60:61]
    v_pk_add_f32 v[54:55], v[54:55], v[62:63]
    v_pk_add_f32 v[32:33], v[32:33], v[48:49]
    v_pk_add_f32 v[34:35], v[34:35], v[50:51]
    v_pk_add_f32 v[36:37], v[36:37], v[52:53]
    v_pk_add_f32 v[38:39], v[38:39], v[54:55]
    s_movk_i32 s69, 0x207
L_fnorm:
    v_mul_f32 v82, v80, v11
    v_pk_mul_f32 v[32:33], v[32:33], v[82:83] op_sel_hi:[1,0]
    v_pk_mul_f32 v[34:35], v[34:35], v[82:83] op_sel_hi:[1,0]
    v_pk_mul_f32 v[36:37], v[36:37], v[82:83] op_sel_hi:[1,0]
    v_pk_mul_f32 v[38:39], v[38:39], v[82:83] op_sel_hi:[1,0]
    v_pk_fma_f32 v[16:17], v[80:81], s[82:83], v[32:33]
    v_pk_fma_f32 v[16:17], v[34:35], v[36:37], v[16:17]
    v_pk_add_f32 v[16:17], v[16:17], v[38:39]
    v_add_f32 v16, v16, v17
    v_cvt_pk_bf16_f32 v84, v32, v33
    v_cvt_pk_bf16_f32 v85, v34, v35
    v_cvt_pk_bf16_f32 v86, v36, v37
    v_cvt_pk_bf16_f32 v87, v38, v39
    v_cmp_class_f32 vcc, v16, s69
    s_cbranch_vccnz L_fb
    s_setpc_b64 s[92:93]
L_smx0:
L_kredo:
    v_mfma_f32_32x32x16_bf16 v[96:111], v[40:43], v[56:59], 0
    v_mfma_f32_32x32x16_bf16 v[112:127], v[44:47], v[60:63], 0
    s_nop 11
    s_call_b64 s[92:93], L_smx
    s_branch L_ksum
L_smx:
    v_max3_f32 v48, v96, v97, v98
    v_max3_f32 v49, -v96, -v97, -v98
    v_max3_f32 v50, v112, v113, v114
    v_max3_f32 v51, -v112, -v113, -v114
    v_max3_f32 v48, v48, v99, v100
    v_max3_f32 v49, v49, -v99, -v100
    v_max3_f32 v50, v50, v115, v116
    v_max3_f32 v51, v51, -v115, -v116
    v_max3_f32 v48, v48, v101, v102
    v_max3_f32 v49, v49, -v101, -v102
    v_max3_f32 v50, v50, v117, v118
    v_max3_f32 v51, v51, -v117, -v118
    v_max_f32 v48, v48, v103
    v_max_f32 v49, v49, -v103
    v_max_f32 v50, v50, v119
    v_max_f32 v51, v51, -v119
    s_nop 1
    v_permlane32_swap_b32 v48, v49
    v_permlane32_swap_b32 v50, v51
    v_max_f32 v48, v48, v49
    v_max_f32 v50, v50, v51
    v_mul_f32 v48, -1.0, v48
    v_mul_f32 v50, -1.0, v50
    v_mov_b32 v49, v48
    v_mov_b32 v51, v50
    s_nop 1
    v_permlane32_swap_b32 v48, v49
    v_permlane32_swap_b32 v50, v51
    v_pk_fma_f32 v[104:105], v[96:97], s[74:75], v[48:49] op_sel:[0,1,1] op_sel_hi:[1,1,1]
    v_pk_fma_f32 v[96:97], v[96:97], s[74:75], v[48:49] op_sel_hi:[1,0,0]
    v_pk_fma_f32 v[106:107], v[98:99], s[74:75], v[48:49] op_sel:[0,1,1] op_sel_hi:[1,1,1]
    v_pk_fma_f32 v[98:99], v[98:99], s[74:75], v[48:49] op_sel_hi:[1,0,0]
    v_pk_fma_f32 v[108:109], v[100:101], s[74:75], v[48:49] op_sel:[0,1,1] op_sel_hi:[1,1,1]
    v_pk_fma_f32 v[100:101], v[100:101], s[74:75], v[48:49] op_sel_hi:[1,0,0]
    v_pk_fma_f32 v[110:111], v[102:103], s[74:75], v[48:49] op_sel:[0,1,1] op_sel_hi:[1,1,1]
    v_pk_fma_f32 v[102:103], v[102:103], s[74:75], v[48:49] op_sel_hi:[1,0,0]
    v_pk_fma_f32 v[120:121], v[112:113], s[74:75], v[50:51] op_sel:[0,1,1] op_sel_hi:[1,1,1]
    v_pk_fma_f32 v[112:113], v[112:113], s[74:75], v[50:51] op_sel_hi:[1,0,0]
    v_pk_fma_f32 v[122:123], v[114:115], s[74:75], v[50:51] op_sel:[0,1,1] op_sel_hi:[1,1,1]
    v_pk_fma_f32 v[114:115], v[114:115], s[74:75], v[50:51] op_sel_hi:[1,0,0]
    v_pk_fma_f32 v[124:125], v[116:117], s[74:75], v[50:51] op_sel:[0,1,1] op_sel_hi:[1,1,1]
    v_pk_fma_f32 v[116:117], v[116:117], s[74:75], v[50:51] op_sel_hi:[1,0,0]
    v_pk_fma_f32 v[126:127], v[118:119], s[74:75], v[50:51] op_sel:[0,1,1] op_sel_hi:[1,1,1]
    v_pk_fma_f32 v[118:119], v[118:119], s[74:75], v[50:51] op_sel_hi:[1,0,0]
    v_exp_f32 v96, v96
    v_exp_f32 v97, v97
    v_exp_f32 v98, v98
    v_exp_f32 v99, v99
    v_exp_f32 v100, v100
    v_exp_f32 v101, v101
    v_exp_f32 v102, v102
    v_exp_f32 v103, v103
    v_exp_f32 v104, v104
    v_exp_f32 v105, v105
    v_exp_f32 v106, v106
    v_exp_f32 v107, v107
    v_exp_f32 v108, v108
    v_exp_f32 v109, v109
    v_exp_f32 v110, v110
    v_exp_f32 v111, v111
    v_exp_f32 v112, v112
    v_exp_f32 v113, v113
    v_exp_f32 v114, v114
    v_exp_f32 v115, v115
    v_exp_f32 v116, v116
    v_exp_f32 v117, v117
    v_exp_f32 v118, v118
    v_exp_f32 v119, v119
    v_exp_f32 v120, v120
    v_exp_f32 v121, v121
    v_exp_f32 v122, v122
    v_exp_f32 v123, v123
    v_exp_f32 v124, v124
    v_exp_f32 v125, v125
    v_exp_f32 v126, v126
    v_exp_f32 v127, v127
    s_setpc_b64 s[92:93]
L_fb:
    s_lshl_b32 s69, s80, 10
    s_add_u32 s69, s69, 18432
    v_add_u32 v16, s69, v1
    ds_read_b128 v[84:87], v16
    v_bfe_u32 v81, v1, 4, 5
    v_lshrrev_b32 v17, 9, v1
    v_bfe_u32 v16, v1, 4, 4
    v_lshl_add_u32 v16, v17, 4, v16
    v_lshlrev_b32 v16, 4, v16
    v_mov_b32 v17, 0x80000000
    v_cmp_gt_u32 vcc, 16, v81
    v_mov_b32 v82, 0x400
    v_mov_b32 v83, 0x200
    v_cndmask_b32 v16, v17, v16, vcc
    v_cmp_eq_u32 vcc, 16, v81
    v_mov_b32 v80, 0xff800000
    s_mov_b32 s69, 0
    v_cndmask_b32 v82, v16, v82, vcc
    v_cndmask_b32 v83, v16, v83, vcc
L_fa60:
    buffer_load_dwordx4 v[88:91], v1, s[24:27], s69 offen sc1
    s_waitcnt vmcnt(0) lgkmcnt(0)
    v_max3_u32 v16, v88, v89, v90
    v_max_u32 v16, v16, v91
    v_cmp_eq_u32 vcc, -1, v16
    s_cbranch_vccz L_fad61
    s_sub_u32 s68, s68, 1
    s_cbranch_scc1 L_fad61_x
    s_sleep 2
    s_branch L_fa60
L_fad61_x:
    s_mov_b32 s68, 0
L_fad61:
    v_mfma_f32_32x32x16_bf16 v[48:63], v[88:91], v[84:87], 0
    s_nop 11
    v_max3_f32 v80, v80, v48, v49
    v_max3_f32 v80, v80, v50, v51
    v_max3_f32 v80, v80, v52, v53
    v_max3_f32 v80, v80, v54, v55
    v_max3_f32 v80, v80, v56, v57
    v_max3_f32 v80, v80, v58, v59
    v_max3_f32 v80, v80, v60, v61
    v_max3_f32 v80, v80, v62, v63
    s_add_u32 s69, s69, 2176
    s_cmp_lt_u32 s69, 139264
    s_cbranch_scc1 L_fa60
    v_mov_b32 v81, v80
    s_nop 1
    v_permlane32_swap_b32 v80, v81
    v_max_f32 v80, v80, v81
    v_mfma_f32_32x32x8_bf16 v[32:47], v[26:27], v[26:27], 0
    s_mov_b32 s69, 0
L_fc62k:
    buffer_load_dwordx4 v[88:91], v1, s[24:27], s69 offen sc1
    s_waitcnt vmcnt(0)
    v_mfma_f32_32x32x16_bf16 v[48:63], v[88:91], v[84:87], 0
L_fc62:
    buffer_load_dwordx4 v[88:91], v82, s[24:27], s69 offen offset:1024 sc1
    buffer_load_dwordx4 v[92:95], v83, s[24:27], s69 offen offset:1536 sc1
    s_waitcnt vmcnt(0)
    v_max3_u32 v16, v88, v89, v90
    v_max3_u32 v16, v16, v91, v92
    v_max3_u32 v16, v16, v93, v94
    v_max_u32 v16, v16, v95
    v_cmp_eq_u32 vcc, -1, v16
    s_cbranch_vccz L_fcd63
    s_sub_u32 s68, s68, 1
    s_cbranch_scc1 L_fcd63_x
    s_sleep 2
    s_branch L_fc62
L_fcd63_x:
    s_mov_b32 s68, 0
L_fcd63:
    s_nop 3
    v_sub_f32 v48, v48, v80
    v_sub_f32 v49, v49, v80
    v_sub_f32 v50, v50, v80
    v_sub_f32 v51, v51, v80
    v_sub_f32 v52, v52, v80
    v_sub_f32 v53, v53, v80
    v_sub_f32 v54, v54, v80
    v_sub_f32 v55, v55, v80
    v_sub_f32 v56, v56, v80
    v_sub_f32 v57, v57, v80
    v_sub_f32 v58, v58, v80
    v_sub_f32 v59, v59, v80
    v_sub_f32 v60, v60, v80
    v_sub_f32 v61, v61, v80
    v_sub_f32 v62, v62, v80
    v_sub_f32 v63, v63, v80
    v_exp_f32 v48, v48
    v_exp_f32 v49, v49
    v_exp_f32 v50, v50
    v_exp_f32 v51, v51
    v_exp_f32 v52, v52
    v_exp_f32 v53, v53
    v_exp_f32 v54, v54
    v_exp_f32 v55, v55
    v_exp_f32 v56, v56
    v_exp_f32 v57, v57
    v_exp_f32 v58, v58
    v_exp_f32 v59, v59
    v_exp_f32 v60, v60
    v_exp_f32 v61, v61
    v_exp_f32 v62, v62
    v_exp_f32 v63, v63
    s_nop 1
    v_smfmac_f32_32x32x32_bf16 v[32:47], v[88:91], v[48:55], v25
    v_smfmac_f32_32x32x32_bf16 v[32:47], v[92:95], v[56:63], v25
    s_add_u32 s69, s69, 2176
    s_cmp_lt_u32 s69, 139264
    s_cbranch_scc1 L_fc62k
    s_nop 11
    v_rcp_f32 v80, v40
    s_nop 0
    v_mov_b32 v81, v80
    s_nop 1
    v_permlane32_swap_b32 v80, v81
    s_mov_b64 s[82:83], 0
    s_mov_b32 s69, 0
    s_branch L_fnorm
L_codeend:
.fill 8, 4, 0xbf810000
.set CODE_BYTES, L_codeend - L_pc
.section .rodata,"a"
.p2align 6
.amdhsa_kernel gated_mix__grouped_kv_mqa__linear_kernel_hedgehog__prompt_kernel
  .amdhsa_next_free_vgpr 256
  .amdhsa_next_free_sgpr 102
  .amdhsa_accum_offset 128
  .amdhsa_group_segment_fixed_size 0
  .amdhsa_kernarg_size 104
  .amdhsa_user_sgpr_count 2
  .amdhsa_user_sgpr_kernarg_segment_ptr 1
  .amdhsa_system_sgpr_workgroup_id_x 1
  .amdhsa_float_denorm_mode_32 3
.end_amdhsa_kernel
```
